```python
import torch

def _softmax(x, axis=-1):
    return torch.softmax(x, dim=axis)
def _gelu(x):
    return torch.nn.functional.gelu(x, approximate="tanh")
def _silu(x):
    return torch.nn.functional.silu(x)
def _sigmoid(x):
    return torch.sigmoid(x)
def _layernorm(x, axis=-1, eps=1e-5):
    m = x.mean(dim=axis, keepdim=True)
    v = x.var(dim=axis, keepdim=True, unbiased=False)
    return (x - m) / torch.sqrt(v + eps)
def _scatter_add(tgt, idx, src, axis=0):
    return tgt.clone().index_add_(axis, idx, src)
def _segment_sum(src, seg, n):
    out = torch.zeros((n,) + src.shape[1:], dtype=src.dtype)
    return out.index_add_(0, seg, src)
def _pad(x, pw):
    flat = tuple(v for pair in reversed(pw) for v in pair)
    return torch.nn.functional.pad(x, flat)

kernel_name = 'concat_heads__spectral_fnet__sliding_local_dilated__prompt'

def setup_inputs():

    _w = (lambda a: (lambda t: t.to(torch.bfloat16) if t.is_floating_point() else t)(torch.as_tensor(a)))
    def _A_setup():
        B, S, D = 1, 2048, 576
        ns = torch.arange(S)[:, None] * torch.arange(S)[None, :]
        nd = torch.arange(D)[:, None] * torch.arange(D)[None, :]
        Ws_re = torch.cos(-2.0 * torch.pi * ns / S).to(float)
        Ws_im = torch.sin(-2.0 * torch.pi * ns / S).to(float)
        Wd_re = torch.cos(-2.0 * torch.pi * nd / D).to(float)
        Wd_im = torch.sin(-2.0 * torch.pi * nd / D).to(float)
        return {
            "x": _w((lambda *s: torch.randn(*s, dtype=torch.bfloat16) * 0.05)(B, S, D)),
            "dft_seq_re": _w(Ws_re),
            "dft_seq_im": _w(Ws_im),
            "dft_hid_re": _w(Wd_re),
            "dft_hid_im": _w(Wd_im),
        }
    _A_in = _A_setup()

    def _B_setup():
        B, S, D = 1, 2048, 576
        return {
            "x": _w((lambda *s: torch.randn(*s, dtype=torch.bfloat16) * 0.2)(B, S, D)),
            "wqkv": _w((lambda *s: torch.randn(*s, dtype=torch.bfloat16) * 0.8)(D, 3 * D)),
            "wo": _w((lambda *s: torch.randn(*s, dtype=torch.bfloat16) * 0.2)(D, D)),
        }
    _B_in = _B_setup()

    return {
        "A_x": _A_in["x"],
        "A_dft_seq_re": _A_in["dft_seq_re"],
        "A_dft_seq_im": _A_in["dft_seq_im"],
        "A_dft_hid_re": _A_in["dft_hid_re"],
        "A_dft_hid_im": _A_in["dft_hid_im"],
        "B_x": _B_in["x"],
        "B_wqkv": _B_in["wqkv"],
        "B_wo": _B_in["wo"],
    }

def reference(A_x, A_dft_seq_re, A_dft_seq_im, A_dft_hid_re, A_dft_hid_im, B_x, B_wqkv, B_wo):
    def _A_ref(x, dft_seq_re, dft_seq_im, dft_hid_re, dft_hid_im):
        a = torch.einsum("bsd,ed->bse", x, dft_hid_re)
        b = torch.einsum("bsd,ed->bse", x, dft_hid_im)
        y = torch.einsum("ts,bse->bte", dft_seq_re, a) - torch.einsum("ts,bse->bte", dft_seq_im, b)
        return y

    def _B_ref(x, wqkv, wo):
        B, S, D = x.shape
        H = 32; Dh = D // H
        W, dil = 8, 2
        qkv = (lambda x, *d: x.permute(*d))((x @ wqkv).reshape(B, S, 3, H, Dh), 2, 0, 3, 1, 4)
        q, k, v = qkv[0], qkv[1], qkv[2]
        scale = Dh ** -0.5
        pos = torch.arange(S)
        off = torch.arange(W) * dil
        idx = pos[:, None] - off[None, :]
        mask = idx >= 0
        idx_c = torch.where(mask, idx, 0).reshape(-1)
        kg = k[:, :, idx_c, :].reshape(B, H, S, W, Dh)
        vg = v[:, :, idx_c, :].reshape(B, H, S, W, Dh)
        logits = torch.einsum("bhsd,bhswd->bhsw", q, kg) * scale
        logits = torch.where(mask[None, None, :, :], logits, -1e9)
        attn = _softmax(logits, axis=-1)
        o = torch.einsum("bhsw,bhswd->bhsd", attn, vg)
        return (lambda x, *d: x.permute(*d))(o, 0, 2, 1, 3).reshape(B, S, D) @ wo

    a = _A_ref(A_x, A_dft_seq_re, A_dft_seq_im, A_dft_hid_re, A_dft_hid_im)
    b = _B_ref(B_x, B_wqkv, B_wo)
    return torch.concatenate([a, b], axis=-1)
```

```asm
; @launch grid=(256,1,1) block=(256,1,1) lds=163840
.amdgcn_target "amdgcn-amd-amdhsa--gfx950"
.text
.globl concat_heads__spectral_fnet__sliding_local_dilated__prompt_kernel
.p2align 8
.type concat_heads__spectral_fnet__sliding_local_dilated__prompt_kernel,@function
concat_heads__spectral_fnet__sliding_local_dilated__prompt_kernel:
    s_cmpk_ge_u32 s2, 256
    s_cbranch_scc1 L_end
    s_load_dwordx16 s[4:19], s[0:1], 0
    s_load_dwordx4 s[20:23], s[0:1], 64
    s_load_dwordx2 s[24:25], s[0:1], 80
    s_getpc_b64 s[26:27]
L_pc0:
    s_andn2_b32 s3, s2, 7
    s_lshl_b32 s61, s3, 7
    v_lshl_add_u32 v1, v0, 2, s61
    v_min_u32 v1, L_end-L_pc0, v1
    global_load_dword a255, v1, s[26:27]
    s_cmpk_ge_u32 s2, 192
    s_cbranch_scc1 L_A
    s_lshl_b32 s61, s2, 2
    s_lshr_b32 s61, 0x41066330, s61
    s_and_b32 s61, s61, 15
    s_lshl_b32 s62, s61, 6
    s_add_u32 s62, s62, s3
    s_and_b32 s63, s2, 1
    v_lshrrev_b32 v1, 5, v0
    v_add_u32 v1, s62, v1
    v_mul_u32_u24 v1, 27, v1
    v_and_b32 v2, 15, v0
    v_min_u32 v2, 14, v2
    v_add_u32 v1, v2, v1
    v_mul_u32_u24 v2, 13, v2
    v_lshrrev_b32 v2, 6, v2
    v_add_u32 v2, s63, v2
    v_lshlrev_b32 v2, 2, v2
    v_add_lshl_u32 v1, v1, v2, 7
    s_waitcnt lgkmcnt(0)
    global_load_dword a254, v1, s[16:17]
    v_lshrrev_b32 v1, 6, v0
    v_and_b32 v0, 63, v0
    v_readfirstlane_b32 s56, v1
    s_and_b32 s57, s2, 7
    s_lshr_b32 s58, s2, 3
    v_and_b32 v1, 15, v0
    v_lshrrev_b32 v2, 4, v0
    s_mov_b32 s46, 7340032
    s_mov_b32 s47, 0x20000
    s_mov_b32 s50, 4718592
    s_mov_b32 s51, 0x20000
    s_mov_b32 s54, 256
    s_mov_b32 s55, 0x20000
    s_lshr_b32 s61, s57, 1
    s_mul_i32 s59, s61, 6
    s_lshr_b32 s61, s58, 2
    s_add_u32 s59, s59, s61
    s_and_b32 s60, s57, 1
    s_lshl_b32 s60, s60, 2
    s_and_b32 s61, s58, 3
    s_add_u32 s60, s60, s61
    s_mul_i32 s101, s59, 88
    s_sub_u32 s101, s101, 8
    s_mov_b32 s30, 2359296
    s_mov_b32 s31, 0x20000
    s_mov_b32 s34, 1990656
    s_mov_b32 s35, 0x20000
    s_mov_b32 s38, 663552
    s_mov_b32 s39, 0x20000
    s_mul_i32 s27, s56, 3072
    s_mul_i32 s3, s56, 7168
    s_add_u32 s3, s3, 12288
    s_mul_i32 s61, s56, 24
    v_lshrrev_b32 v3, 3, v0
    v_add_u32 v3, s61, v3
    v_and_b32 v4, 7, v0
    v_mov_b32 v9, 2147483648
    v_add_u32 v5, 0, v3
    v_bfe_u32 v6, v5, 1, 3
    v_xor_b32 v6, v6, v4
    v_add_u32 v5, s101, v5
    v_and_b32 v7, 1023, v5
    v_lshrrev_b32 v8, 10, v5
    v_lshl_or_b32 v7, v7, 1, v8
    v_cmp_gt_u32 vcc, 2048, v5
    v_mul_u32_u24 v7, 1152, v7
    v_lshl_add_u32 v7, v6, 4, v7
    v_cndmask_b32 v10, v9, v7, vcc
    v_add_u32 v5, 8, v3
    v_bfe_u32 v6, v5, 1, 3
    v_xor_b32 v6, v6, v4
    v_add_u32 v5, s101, v5
    v_and_b32 v7, 1023, v5
    v_lshrrev_b32 v8, 10, v5
    v_lshl_or_b32 v7, v7, 1, v8
    v_cmp_gt_u32 vcc, 2048, v5
    v_mul_u32_u24 v7, 1152, v7
    v_lshl_add_u32 v7, v6, 4, v7
    v_cndmask_b32 v11, v9, v7, vcc
    v_add_u32 v5, 16, v3
    v_bfe_u32 v6, v5, 1, 3
    v_xor_b32 v6, v6, v4
    v_add_u32 v5, s101, v5
    v_and_b32 v7, 1023, v5
    v_lshrrev_b32 v8, 10, v5
    v_lshl_or_b32 v7, v7, 1, v8
    v_cmp_gt_u32 vcc, 2048, v5
    v_mul_u32_u24 v7, 1152, v7
    v_lshl_add_u32 v7, v6, 4, v7
    v_cndmask_b32 v12, v9, v7, vcc
    s_mul_i32 s61, s56, 55296
    s_mul_i32 s62, s60, 144
    s_add_u32 s61, s61, s62
    s_mov_b32 s66, 0
    s_mov_b32 s67, 0
    s_mov_b32 s64, s27
    s_mov_b32 s65, s3
    s_lshl_b32 s68, s57, 2
    s_lshr_b32 s79, 0x41066330, s68
    s_and_b32 s79, s79, 15
    s_lshr_b32 s62, s58, 2
    s_and_b32 s63, s58, 3
    s_add_u32 s62, s62, s63
    s_lshl_b32 s62, s62, 2
    s_mov_b32 s68, 0x10543210
    s_mov_b32 s69, 2
    s_lshr_b64 s[68:69], s[68:69], s62
    s_and_b32 s62, s68, 15
    s_mov_b32 s69, 0x76542130
    s_mov_b32 s68, 8
    s_cmp_eq_u32 s62, 1
    s_cselect_b32 s69, 0x76530421, s69
    s_cmp_eq_u32 s62, 2
    s_cselect_b32 s69, 0x76435102, s69
    s_cmp_eq_u32 s62, 3
    s_cselect_b32 s69, 0x75463210, s69
    s_cmp_eq_u32 s62, 4
    s_cselect_b32 s69, 0x65743021, s69
    s_cmp_eq_u32 s62, 5
    s_cselect_b32 s69, 0x68543102, s69
    s_cselect_b32 s68, 7, s68
    s_waitcnt lgkmcnt(0)
    s_mov_b64 s[28:29], s[14:15]
    s_mov_b64 s[32:33], s[16:17]
    s_mov_b64 s[36:37], s[18:19]
    s_mov_b64 s[44:45], s[24:25]
    s_mov_b64 s[48:49], s[20:21]
    s_mov_b64 s[52:53], s[22:23]
    s_mov_b32 s8, s69
    s_mov_b32 s9, s68
    s_mov_b32 s10, s79
    s_and_b32 s69, s8, 15
    s_lshr_b64 s[8:9], s[8:9], 4
    s_add_u32 s69, s69, s10
    s_sub_u32 s68, s69, 9
    s_min_u32 s69, s69, s68
    s_mul_i32 s68, s69, 128
    s_mul_i32 s69, s69, 221184
    s_add_u32 m0, s64, 0
    s_nop 0
    buffer_load_dwordx4 v10, s[28:31], s68 offen  lds
    s_add_u32 m0, s64, 1024
    s_nop 0
    buffer_load_dwordx4 v11, s[28:31], s68 offen  lds
    s_add_u32 m0, s64, 2048
    s_nop 0
    buffer_load_dwordx4 v12, s[28:31], s68 offen  lds
    v_add_u32 v3, 0, v0
    v_mul_u32_u24 v4, 2428, v3
    v_lshrrev_b32 v4, 16, v4
    v_mul_u32_u24 v5, 27, v4
    v_sub_u32 v5, v3, v5
    v_mul_u32_u24 v6, 7282, v5
    v_lshrrev_b32 v6, 16, v6
    v_mul_u32_u24 v6, 1008, v6
    v_lshl_add_u32 v5, v5, 4, v6
    v_bfe_u32 v6, v4, 1, 2
    v_and_b32 v7, 1, v4
    v_lshl_or_b32 v6, v7, 2, v6
    v_and_or_b32 v6, v4, 8, v6
    v_mul_u32_u24 v6, 3456, v6
    v_add3_u32 v13, v5, v6, s61
    s_add_u32 m0, s65, 0
    s_nop 0
    buffer_load_dwordx4 v13, s[32:35], s69 offen  lds
    v_add_u32 v3, 64, v0
    v_mul_u32_u24 v4, 2428, v3
    v_lshrrev_b32 v4, 16, v4
    v_mul_u32_u24 v5, 27, v4
    v_sub_u32 v5, v3, v5
    v_mul_u32_u24 v6, 7282, v5
    v_lshrrev_b32 v6, 16, v6
    v_mul_u32_u24 v6, 1008, v6
    v_lshl_add_u32 v5, v5, 4, v6
    v_bfe_u32 v6, v4, 1, 2
    v_and_b32 v7, 1, v4
    v_lshl_or_b32 v6, v7, 2, v6
    v_and_or_b32 v6, v4, 8, v6
    v_mul_u32_u24 v6, 3456, v6
    v_add3_u32 v14, v5, v6, s61
    s_add_u32 m0, s65, 1024
    s_nop 0
    buffer_load_dwordx4 v14, s[32:35], s69 offen  lds
    v_add_u32 v3, 128, v0
    v_mul_u32_u24 v4, 2428, v3
    v_lshrrev_b32 v4, 16, v4
    v_mul_u32_u24 v5, 27, v4
    v_sub_u32 v5, v3, v5
    v_mul_u32_u24 v6, 7282, v5
    v_lshrrev_b32 v6, 16, v6
    v_mul_u32_u24 v6, 1008, v6
    v_lshl_add_u32 v5, v5, 4, v6
    v_bfe_u32 v6, v4, 1, 2
    v_and_b32 v7, 1, v4
    v_lshl_or_b32 v6, v7, 2, v6
    v_and_or_b32 v6, v4, 8, v6
    v_mul_u32_u24 v6, 3456, v6
    v_add3_u32 v15, v5, v6, s61
    s_add_u32 m0, s65, 2048
    s_nop 0
    buffer_load_dwordx4 v15, s[32:35], s69 offen  lds
    v_add_u32 v3, 192, v0
    v_mul_u32_u24 v4, 2428, v3
    v_lshrrev_b32 v4, 16, v4
    v_mul_u32_u24 v5, 27, v4
    v_sub_u32 v5, v3, v5
    v_mul_u32_u24 v6, 7282, v5
    v_lshrrev_b32 v6, 16, v6
    v_mul_u32_u24 v6, 1008, v6
    v_lshl_add_u32 v5, v5, 4, v6
    v_bfe_u32 v6, v4, 1, 2
    v_and_b32 v7, 1, v4
    v_lshl_or_b32 v6, v7, 2, v6
    v_and_or_b32 v6, v4, 8, v6
    v_mul_u32_u24 v6, 3456, v6
    v_add3_u32 v16, v5, v6, s61
    s_add_u32 m0, s65, 3072
    s_nop 0
    buffer_load_dwordx4 v16, s[32:35], s69 offen  lds
    v_add_u32 v3, 256, v0
    v_mul_u32_u24 v4, 2428, v3
    v_lshrrev_b32 v4, 16, v4
    v_mul_u32_u24 v5, 27, v4
    v_sub_u32 v5, v3, v5
    v_mul_u32_u24 v6, 7282, v5
    v_lshrrev_b32 v6, 16, v6
    v_mul_u32_u24 v6, 1008, v6
    v_lshl_add_u32 v5, v5, 4, v6
    v_bfe_u32 v6, v4, 1, 2
    v_and_b32 v7, 1, v4
    v_lshl_or_b32 v6, v7, 2, v6
    v_and_or_b32 v6, v4, 8, v6
    v_mul_u32_u24 v6, 3456, v6
    v_add3_u32 v17, v5, v6, s61
    v_add_u32 v3, 320, v0
    v_mul_u32_u24 v4, 2428, v3
    v_lshrrev_b32 v4, 16, v4
    v_mul_u32_u24 v5, 27, v4
    v_sub_u32 v5, v3, v5
    v_mul_u32_u24 v6, 7282, v5
    v_lshrrev_b32 v6, 16, v6
    v_mul_u32_u24 v6, 1008, v6
    v_lshl_add_u32 v5, v5, 4, v6
    v_bfe_u32 v6, v4, 1, 2
    v_and_b32 v7, 1, v4
    v_lshl_or_b32 v6, v7, 2, v6
    v_and_or_b32 v6, v4, 8, v6
    v_mul_u32_u24 v6, 3456, v6
    v_add3_u32 v18, v5, v6, s61
    v_add_u32 v3, 384, v0
    v_mul_u32_u24 v4, 2428, v3
    v_lshrrev_b32 v4, 16, v4
    v_mul_u32_u24 v5, 27, v4
    v_sub_u32 v5, v3, v5
    v_mul_u32_u24 v6, 7282, v5
    v_lshrrev_b32 v6, 16, v6
    v_mul_u32_u24 v6, 1008, v6
    v_lshl_add_u32 v5, v5, 4, v6
    v_bfe_u32 v6, v4, 1, 2
    v_and_b32 v7, 1, v4
    v_lshl_or_b32 v6, v7, 2, v6
    v_and_or_b32 v6, v4, 8, v6
    v_mul_u32_u24 v6, 3456, v6
    v_add3_u32 v19, v5, v6, s61
    v_cmp_gt_u32 vcc, 48, v0
    s_nop 1
    v_cndmask_b32 v19, v9, v19, vcc
    s_lshr_b32 s61, s56, 1
    s_mul_i32 s61, s61, 48
    s_and_b32 s62, s56, 1
    v_add_u32 v3, s61, v1
    v_lshrrev_b32 v4, 1, v1
    v_xor_b32 v4, v4, v2
    v_lshlrev_b32 v4, 4, v4
    v_lshl_add_u32 v24, v3, 7, v4
    v_xor_b32 v25, 64, v24
    v_lshrrev_b32 v4, 1, v2
    v_mul_u32_u24 v4, 7168, v4
    v_and_b32 v5, 1, v2
    v_bfe_u32 v6, v0, 2, 2
    v_lshl_add_u32 v5, v5, 2, v6
    v_mul_u32_u24 v5, 864, v5
    s_mul_i32 s63, s62, 72
    s_add_u32 s63, s63, 12288
    v_add3_u32 v4, v4, v5, s63
    v_and_b32 v5, 3, v0
    v_lshl_add_u32 v26, v5, 3, v4
    v_cmp_eq_u32 vcc, 3, v5
    s_nop 1
    v_cndmask_b32 v5, v5, 1, vcc
    v_mul_u32_u24 v5, 144, v5
    v_add3_u32 v27, v4, v5, 32
    v_mov_b32 v20, v24
    v_mov_b32 v21, v25
    v_mov_b32 v22, v26
    v_mov_b32 v23, v27
    v_mov_b32 v108, 0
    v_mov_b32 v109, 0
    v_mov_b32 v110, 0
    v_mov_b32 v111, 0
    v_mov_b32 v8, 0xf149f2ca
    v_mov_b32 v9, 2147483648
    s_lshl_b32 s63, s60, 1
    v_mfma_f32_32x32x16_bf16 v[112:127], v[108:111], v[108:111], 0
    s_add_u32 s63, s63, s62
    s_lshl_b32 s96, s63, 10
    s_mul_i32 s97, s63, 384
    s_mul_i32 s63, s59, 12288
    s_add_u32 s97, s97, s63
    s_lshl_b32 s63, s61, 7
    s_add_u32 s97, s97, s63
    s_add_u32 s97, s97, 2097152
    v_lshl_add_u32 v7, v0, 3, s97
    v_cmp_gt_u32 vcc, 48, v0
    s_nop 1
    v_cndmask_b32 v243, v9, v7, vcc
    v_mfma_f32_32x32x16_bf16 v[128:143], v[108:111], v[108:111], 0
    v_lshlrev_b32 v7, 2, v2
    v_sub_u32 v7, v1, v7
    v_subrev_u32 v6, 0, v7
    v_and_b32 v228, 15, v6
    v_subrev_u32 v6, 1, v7
    v_and_b32 v229, 15, v6
    v_subrev_u32 v6, 2, v7
    v_and_b32 v230, 15, v6
    v_subrev_u32 v6, 3, v7
    v_and_b32 v231, 15, v6
    v_mfma_f32_32x32x16_bf16 v[144:159], v[108:111], v[108:111], 0
    v_add_u32 v4, 0, v3
    v_add_u32 v5, s101, v4
    v_and_b32 v6, 1023, v5
    v_min_u32 v6, 7, v6
    v_cmp_le_u32 s[70:71], v228, v6
    v_cmp_le_u32 s[72:73], v229, v6
    v_cmp_le_u32 s[74:75], v230, v6
    v_cmp_le_u32 s[76:77], v231, v6
    v_cndmask_b32 v216, v8, 0, s[70:71]
    v_cndmask_b32 v217, v8, 0, s[72:73]
    v_cndmask_b32 v218, v8, 0, s[74:75]
    v_cndmask_b32 v219, v8, 0, s[76:77]
    v_lshrrev_b32 v6, 4, v5
    v_lshlrev_b32 v6, 14, v6
    v_and_b32 v7, 15, v5
    v_lshl_add_u32 v6, v7, 4, v6
    v_cmp_le_u32 vcc, 8, v4
    v_mov_b32 v7, 2048
    v_cmp_gt_u32 s[70:71], v7, v5
    s_nop 0
    s_and_b64 vcc, vcc, s[70:71]
    v_lshl_add_u32 v7, v2, 8, v6
    v_add_u32 v7, s96, v7
    v_cndmask_b32 v240, v9, v7, vcc
    v_mov_b32 v195, 0
    v_mov_b32 v197, 0
    v_mfma_f32_32x32x16_bf16 v[160:175], v[108:111], v[108:111], 0
    v_add_u32 v4, 16, v3
    v_add_u32 v5, s101, v4
    v_and_b32 v6, 1023, v5
    v_min_u32 v6, 7, v6
    v_cmp_le_u32 s[70:71], v228, v6
    v_cmp_le_u32 s[72:73], v229, v6
    v_cmp_le_u32 s[74:75], v230, v6
    v_cmp_le_u32 s[76:77], v231, v6
    v_cndmask_b32 v220, v8, 0, s[70:71]
    v_cndmask_b32 v221, v8, 0, s[72:73]
    v_cndmask_b32 v222, v8, 0, s[74:75]
    v_cndmask_b32 v223, v8, 0, s[76:77]
    v_lshrrev_b32 v6, 4, v5
    v_lshlrev_b32 v6, 14, v6
    v_and_b32 v7, 15, v5
    v_lshl_add_u32 v6, v7, 4, v6
    v_cmp_le_u32 vcc, 8, v4
    v_mov_b32 v7, 2048
    v_cmp_gt_u32 s[70:71], v7, v5
    s_nop 0
    s_and_b64 vcc, vcc, s[70:71]
    v_lshl_add_u32 v7, v2, 8, v6
    v_add_u32 v7, s96, v7
    v_cndmask_b32 v241, v9, v7, vcc
    v_mov_b32 v203, 0
    v_mov_b32 v205, 0
    v_mfma_f32_32x32x16_bf16 v[176:191], v[108:111], v[108:111], 0
    v_add_u32 v4, 32, v3
    v_add_u32 v5, s101, v4
    v_and_b32 v6, 1023, v5
    v_min_u32 v6, 7, v6
    v_cmp_le_u32 s[70:71], v228, v6
    v_cmp_le_u32 s[72:73], v229, v6
    v_cmp_le_u32 s[74:75], v230, v6
    v_cmp_le_u32 s[76:77], v231, v6
    v_cndmask_b32 v224, v8, 0, s[70:71]
    v_cndmask_b32 v225, v8, 0, s[72:73]
    v_cndmask_b32 v226, v8, 0, s[74:75]
    v_cndmask_b32 v227, v8, 0, s[76:77]
    v_lshrrev_b32 v6, 4, v5
    v_lshlrev_b32 v6, 14, v6
    v_and_b32 v7, 15, v5
    v_lshl_add_u32 v6, v7, 4, v6
    v_cmp_le_u32 vcc, 8, v4
    v_mov_b32 v7, 2048
    v_cmp_gt_u32 s[70:71], v7, v5
    s_nop 0
    s_and_b64 vcc, vcc, s[70:71]
    v_lshl_add_u32 v7, v2, 8, v6
    v_add_u32 v7, s96, v7
    v_cndmask_b32 v242, v9, v7, vcc
    v_mov_b32 v211, 0
    v_mov_b32 v213, 0
    v_lshl_add_u32 v7, v2, 2, 0
    v_cmp_gt_u32 s[70:71], v7, v1
    v_lshl_add_u32 v7, v2, 2, 1
    v_cmp_gt_u32 s[72:73], v7, v1
    v_lshl_add_u32 v7, v2, 2, 2
    v_cmp_gt_u32 s[74:75], v7, v1
    v_lshl_add_u32 v7, v2, 2, 3
    v_cmp_gt_u32 s[76:77], v7, v1
    v_mov_b32 v4, 0xffff
    v_mov_b32 v5, 0xffff0000
    v_cndmask_b32 v6, 0, v4, s[70:71]
    v_cndmask_b32 v7, 0, v5, s[72:73]
    v_or_b32 v236, v6, v7
    v_cndmask_b32 v6, 0, v4, s[74:75]
    v_cndmask_b32 v7, 0, v5, s[76:77]
    v_or_b32 v237, v6, v7
    v_cmp_eq_u32 s[78:79], 0, v2
    v_cmp_eq_u32 vcc, 1, v2
    s_nop 0
    v_cndmask_b32 v238, 0, -1, s[78:79]
    v_cndmask_b32 v239, 0, -1, vcc
    s_mov_b32 s78, 0xffff
    s_mov_b32 s79, 0xffff
    v_mov_b32 v228, 0
    v_mov_b32 v229, 0
    v_mov_b32 v230, 0
    v_mov_b32 v231, 0
    s_mov_b32 s63, 0x3f80
    v_writelane_b32 v231, s63, 32
    v_writelane_b32 v231, s63, 52
    v_writelane_b32 v231, 1.0, 33
    v_writelane_b32 v231, 1.0, 53
    v_writelane_b32 v231, s63, 40
    v_writelane_b32 v231, s63, 60
    v_writelane_b32 v231, 1.0, 41
    v_writelane_b32 v231, 1.0, 61
    v_and_b32 v4, 3, v0
    v_cmp_eq_u32 vcc, 2, v4
    s_nop 1
    v_cndmask_b32 v232, 0, 1.0, vcc
    v_cndmask_b32 v233, 0, 1.0, vcc
    v_cndmask_b32 v234, 0, 1.0, vcc
    v_cndmask_b32 v235, 0, 1.0, vcc
    s_mul_i32 s63, s56, 3072
    s_add_u32 s63, s63, 151552
    v_lshl_add_u32 v252, v0, 3, s63
    s_mul_i32 s63, s62, 3072
    s_add_u32 s63, s63, 151552
    v_lshl_add_u32 v253, v0, 3, s63
    s_mul_i32 s61, s58, 43
    s_lshr_b32 s61, s61, 8
    s_mul_i32 s62, s61, 6
    s_sub_u32 s100, s58, s62
    s_lshl_b32 s62, s57, 2
    s_add_u32 s61, s61, s62
    s_lshl_b32 s61, s61, 2
    s_add_u32 s58, s61, s56
    s_mul_i32 s100, s100, 192
    s_and_b32 s61, s56, 1
    s_lshl_b32 s61, s61, 1
    s_lshr_b32 s62, s56, 1
    v_add_u32 v3, 0, v0
    v_mul_u32_u24 v4, 5462, v3
    v_lshrrev_b32 v4, 16, v4
    v_mul_u32_u24 v5, 12, v4
    v_sub_u32 v5, v3, v5
    v_lshrrev_b32 v6, 3, v4
    s_add_u32 m0, s65, 4096
    s_nop 0
    buffer_load_dwordx4 v17, s[32:35], s69 offen  lds
    v_lshlrev_b32 v7, 1, v6
    v_xor_b32 v5, v5, v7
    v_lshl_add_u32 v5, v5, 4, s100
    v_add_u32 v6, s61, v6
    v_bfe_u32 v7, v4, 2, 1
    v_and_b32 v4, 3, v4
    s_add_u32 m0, s65, 5120
    s_nop 0
    buffer_load_dwordx4 v18, s[32:35], s69 offen  lds
    v_lshl_add_u32 v3, v6, 2, v4
    v_mad_u32_u24 v3, v7, 20, v3
    s_mul_i32 s63, s62, 36
    v_add_u32 v3, s63, v3
    v_mul_u32_u24 v3, 1152, v3
    v_add_u32 v246, v3, v5
    v_lshl_add_u32 v3, v6, 1, v7
    s_lshl_b32 s63, s62, 3
    s_add_u32 m0, s65, 6144
    s_nop 0
    buffer_load_dwordx4 v19, s[32:35], s69 offen  lds
    s_add_u32 s66, s66, 40960
    s_cmp_eq_u32 s66, 163840
    s_cselect_b32 s66, 0, s66
    s_add_u32 s64, s66, s27
    s_add_u32 s65, s66, s3
    s_and_b32 s69, s8, 15
    s_lshr_b64 s[8:9], s[8:9], 4
    s_add_u32 s69, s69, s10
    s_sub_u32 s68, s69, 9
    s_min_u32 s69, s69, s68
    s_mul_i32 s68, s69, 128
    s_mul_i32 s69, s69, 221184
    v_add_u32 v3, s63, v3
    v_mad_u32_u24 v3, v3, 36, v4
    v_add_u32 v3, 16, v3
    v_mul_u32_u24 v3, 1152, v3
    v_add_u32 v249, v3, v5
    v_add_u32 v3, 64, v0
    v_mul_u32_u24 v4, 5462, v3
    s_add_u32 m0, s64, 0
    s_nop 0
    buffer_load_dwordx4 v10, s[28:31], s68 offen  lds
    v_lshrrev_b32 v4, 16, v4
    v_mul_u32_u24 v5, 12, v4
    v_sub_u32 v5, v3, v5
    v_lshrrev_b32 v6, 3, v4
    v_lshlrev_b32 v7, 1, v6
    v_xor_b32 v5, v5, v7
    s_add_u32 m0, s64, 1024
    s_nop 0
    buffer_load_dwordx4 v11, s[28:31], s68 offen  lds
    v_lshl_add_u32 v5, v5, 4, s100
    v_add_u32 v6, s61, v6
    v_bfe_u32 v7, v4, 2, 1
    v_and_b32 v4, 3, v4
    v_lshl_add_u32 v3, v6, 2, v4
    v_mad_u32_u24 v3, v7, 20, v3
    s_mul_i32 s63, s62, 36
    v_add_u32 v3, s63, v3
    s_add_u32 m0, s64, 2048
    s_nop 0
    buffer_load_dwordx4 v12, s[28:31], s68 offen  lds
    v_mul_u32_u24 v3, 1152, v3
    v_add_u32 v247, v3, v5
    v_lshl_add_u32 v3, v6, 1, v7
    s_lshl_b32 s63, s62, 3
    v_add_u32 v3, s63, v3
    v_mad_u32_u24 v3, v3, 36, v4
    v_add_u32 v3, 16, v3
    s_add_u32 m0, s65, 0
    s_nop 0
    buffer_load_dwordx4 v13, s[32:35], s69 offen  lds
    v_mul_u32_u24 v3, 1152, v3
    v_add_u32 v250, v3, v5
    v_add_u32 v3, 128, v0
    v_mul_u32_u24 v4, 5462, v3
    v_lshrrev_b32 v4, 16, v4
    v_mul_u32_u24 v5, 12, v4
    v_sub_u32 v5, v3, v5
    s_add_u32 m0, s65, 1024
    s_nop 0
    buffer_load_dwordx4 v14, s[32:35], s69 offen  lds
    v_lshrrev_b32 v6, 3, v4
    v_lshlrev_b32 v7, 1, v6
    v_xor_b32 v5, v5, v7
    v_lshl_add_u32 v5, v5, 4, s100
    v_add_u32 v6, s61, v6
    v_bfe_u32 v7, v4, 2, 1
    s_add_u32 m0, s65, 2048
    s_nop 0
    buffer_load_dwordx4 v15, s[32:35], s69 offen  lds
    v_and_b32 v4, 3, v4
    v_lshl_add_u32 v3, v6, 2, v4
    v_mad_u32_u24 v3, v7, 20, v3
    s_mul_i32 s63, s62, 36
    v_add_u32 v3, s63, v3
    v_mul_u32_u24 v3, 1152, v3
    v_add_u32 v248, v3, v5
    v_lshl_add_u32 v3, v6, 1, v7
    s_lshl_b32 s63, s62, 3
    s_add_u32 m0, s65, 3072
    s_nop 0
    buffer_load_dwordx4 v16, s[32:35], s69 offen  lds
    v_add_u32 v3, s63, v3
    v_mad_u32_u24 v3, v3, 36, v4
    v_add_u32 v3, 16, v3
    v_mul_u32_u24 v3, 1152, v3
    v_add_u32 v251, v3, v5
    s_and_b32 s96, s57, 1
    s_mul_i32 s96, s96, 331776
    s_sub_u32 s97, 331776, s96
    v_bfe_u32 v3, v0, 3, 1
    s_add_u32 m0, s65, 4096
    s_nop 0
    buffer_load_dwordx4 v17, s[32:35], s69 offen  lds
    v_and_b32 v4, 7, v0
    v_lshlrev_b32 v4, 2, v4
    v_lshl_add_u32 v255, v3, 7, v4
    s_min_u32 s11, s56, 1
    s_lshl_b32 s12, s11, 31
    s_sub_u32 s11, 0, s11
    v_or_b32 v255, s12, v255
    v_bfe_u32 v5, v0, 2, 2
    v_lshl_add_u32 v5, v2, 3, v5
    v_mul_u32_u24 v5, 192, v5
    s_add_u32 m0, s65, 5120
    s_nop 0
    buffer_load_dwordx4 v18, s[32:35], s69 offen  lds
    v_and_b32 v6, 3, v0
    v_lshl_add_u32 v5, v6, 3, v5
    v_add_u32 v5, 40960, v5
    v_and_b32 v6, 1, v2
    v_lshlrev_b32 v6, 5, v6
    v_add_u32 v3, v5, v6
    s_add_u32 m0, s65, 6144
    s_nop 0
    buffer_load_dwordx4 v19, s[32:35], s69 offen  lds
    s_add_u32 s66, s66, 40960
    s_cmp_eq_u32 s66, 163840
    s_cselect_b32 s66, 0, s66
    s_add_u32 s64, s66, s27
    s_add_u32 s65, s66, s3
    s_and_b32 s69, s8, 15
    s_lshr_b64 s[8:9], s[8:9], 4
    s_add_u32 s69, s69, s10
    s_sub_u32 s68, s69, 9
    s_min_u32 s69, s69, s68
    s_mul_i32 s68, s69, 128
    s_mul_i32 s69, s69, 221184
    v_sub_u32 v4, v5, v6
    v_accvgpr_write_b32 a0, v3
    v_accvgpr_write_b32 a1, v4
    v_add_u32 v3, 61440, v3
    v_add_u32 v4, 61440, v4
    v_accvgpr_write_b32 a2, v3
    v_accvgpr_write_b32 a3, v4
    s_lshl_b32 s61, s58, 14
    s_add_u32 m0, s64, 0
    s_nop 0
    buffer_load_dwordx4 v10, s[28:31], s68 offen  lds
    v_lshl_add_u32 v3, v0, 4, s61
    v_accvgpr_write_b32 a4, v3
    s_lshl_b32 s61, s58, 4
    v_add_u32 v8, s61, v1
    v_and_b32 v7, 1023, v8
    v_lshrrev_b32 v5, 10, v8
    v_lshl_or_b32 v5, v7, 1, v5
    s_add_u32 m0, s64, 1024
    s_nop 0
    buffer_load_dwordx4 v11, s[28:31], s68 offen  lds
    v_mul_u32_u24 v5, 2304, v5
    v_lshrrev_b32 v7, 1, v2
    v_lshl_add_u32 v6, v7, 4, v6
    v_add3_u32 v3, v5, v6, s100
    v_accvgpr_write_b32 a5, v3
    v_lshrrev_b32 v3, 3, v8
    v_mul_u32_u24 v4, 5958, v3
    s_add_u32 m0, s64, 2048
    s_nop 0
    buffer_load_dwordx4 v12, s[28:31], s68 offen  lds
    v_lshrrev_b32 v4, 16, v4
    v_mul_u32_u24 v6, 88, v4
    v_sub_u32 v5, v8, v6
    v_cmp_le_u32 vcc, 40, v5
    v_mov_b32 v6, 5760
    s_nop 0
    v_cndmask_b32 v6, 0, v6, vcc
    s_add_u32 m0, s65, 0
    s_nop 0
    buffer_load_dwordx4 v13, s[32:35], s69 offen  lds
    v_mul_u32_u24 v4, 12288, v4
    v_lshl_add_u32 v4, v5, 3, v4
    v_mul_u32_u24 v5, 768, v2
    v_add3_u32 v4, v4, v5, v6
    v_add_u32 v4, 2097216, v4
    v_accvgpr_write_b32 a6, v4
    s_waitcnt vmcnt(14)
    s_barrier
    ds_read_b64_tr_b16 v[40:41], v22 offset:0
    ds_read_b64_tr_b16 v[42:43], v22 offset:432
    ds_read_b128 v[28:31], v20 offset:0
    ds_read_b128 v[32:35], v20 offset:2048
    ds_read_b128 v[36:39], v20 offset:4096
    ds_read_b64_tr_b16 v[44:45], v22 offset:40
    ds_read_b64_tr_b16 v[46:47], v22 offset:472
    ds_read_b64_tr_b16 v[48:49], v22 offset:144
    ds_read_b64_tr_b16 v[50:51], v22 offset:576
    ds_read_b64_tr_b16 v[52:53], v22 offset:184
    ds_read_b64_tr_b16 v[54:55], v22 offset:616
    ds_read_b64_tr_b16 v[56:57], v23 offset:0
    ds_read_b64_tr_b16 v[58:59], v23 offset:432
    ds_read_b64_tr_b16 v[60:61], v22 offset:288
    ds_read_b64_tr_b16 v[62:63], v22 offset:720
    ds_read_b64_tr_b16 v[64:65], v22 offset:328
    ds_read_b64_tr_b16 v[66:67], v22 offset:760
    s_mov_b32 s26, 6
L_loop_1:
    s_waitcnt lgkmcnt(0)
    v_mfma_f32_16x16x32_bf16 v[108:111], v[40:43], v[28:31], v[108:111]
    s_add_u32 m0, s65, 1024
    ds_read_b64_tr_b16 v[80:81], v22 offset:14336
    v_mfma_f32_16x16x32_bf16 v[112:115], v[44:47], v[28:31], v[112:115]
    buffer_load_dwordx4 v14, s[32:35], s69 offen  lds
    ds_read_b64_tr_b16 v[82:83], v22 offset:14768
    v_mfma_f32_16x16x32_bf16 v[116:119], v[48:51], v[28:31], v[116:119]
    ds_read_b128 v[68:71], v21 offset:0
    ds_read_b128 v[72:75], v21 offset:2048
    v_mfma_f32_16x16x32_bf16 v[120:123], v[52:55], v[28:31], v[120:123]
    ds_read_b128 v[76:79], v21 offset:4096
    ds_read_b64_tr_b16 v[84:85], v22 offset:14376
    v_mfma_f32_16x16x32_bf16 v[124:127], v[56:59], v[28:31], v[124:127]
    s_add_u32 m0, s65, 2048
    ds_read_b64_tr_b16 v[86:87], v22 offset:14808
    v_mfma_f32_16x16x32_bf16 v[128:131], v[28:31], v[60:63], v[128:131]
    buffer_load_dwordx4 v15, s[32:35], s69 offen  lds
    ds_read_b64_tr_b16 v[88:89], v22 offset:14480
    v_mfma_f32_16x16x32_bf16 v[132:135], v[28:31], v[64:67], v[132:135]
    ds_read_b64_tr_b16 v[90:91], v22 offset:14912
    ds_read_b64_tr_b16 v[92:93], v22 offset:14520
    v_mfma_f32_16x16x32_bf16 v[136:139], v[40:43], v[32:35], v[136:139]
    ds_read_b64_tr_b16 v[94:95], v22 offset:14952
    ds_read_b64_tr_b16 v[96:97], v23 offset:14336
    v_mfma_f32_16x16x32_bf16 v[140:143], v[44:47], v[32:35], v[140:143]
    s_add_u32 m0, s65, 3072
    ds_read_b64_tr_b16 v[98:99], v23 offset:14768
    v_mfma_f32_16x16x32_bf16 v[144:147], v[48:51], v[32:35], v[144:147]
    buffer_load_dwordx4 v16, s[32:35], s69 offen  lds
    ds_read_b64_tr_b16 v[100:101], v22 offset:14624
    v_mfma_f32_16x16x32_bf16 v[148:151], v[52:55], v[32:35], v[148:151]
    ds_read_b64_tr_b16 v[102:103], v22 offset:15056
    ds_read_b64_tr_b16 v[104:105], v22 offset:14664
    v_mfma_f32_16x16x32_bf16 v[152:155], v[56:59], v[32:35], v[152:155]
    ds_read_b64_tr_b16 v[106:107], v22 offset:15096
    v_mfma_f32_16x16x32_bf16 v[156:159], v[32:35], v[60:63], v[156:159]
    s_add_u32 m0, s65, 4096
    v_mfma_f32_16x16x32_bf16 v[160:163], v[32:35], v[64:67], v[160:163]
    buffer_load_dwordx4 v17, s[32:35], s69 offen  lds
    v_mfma_f32_16x16x32_bf16 v[164:167], v[40:43], v[36:39], v[164:167]
    s_add_u32 s67, s67, 40960
    s_cmp_eq_u32 s67, 163840
    s_cselect_b32 s67, 0, s67
    v_mfma_f32_16x16x32_bf16 v[168:171], v[44:47], v[36:39], v[168:171]
    v_mfma_f32_16x16x32_bf16 v[172:175], v[48:51], v[36:39], v[172:175]
    s_add_u32 m0, s65, 5120
    v_mfma_f32_16x16x32_bf16 v[176:179], v[52:55], v[36:39], v[176:179]
    buffer_load_dwordx4 v18, s[32:35], s69 offen  lds
    v_mfma_f32_16x16x32_bf16 v[180:183], v[56:59], v[36:39], v[180:183]
    v_add_u32 v20, s67, v24
    v_add_u32 v21, s67, v25
    v_mfma_f32_16x16x32_bf16 v[184:187], v[36:39], v[60:63], v[184:187]
    v_add_u32 v22, s67, v26
    v_add_u32 v23, s67, v27
    v_mfma_f32_16x16x32_bf16 v[188:191], v[36:39], v[64:67], v[188:191]
    s_waitcnt vmcnt(9) lgkmcnt(0)
    s_barrier
    v_mfma_f32_16x16x32_bf16 v[108:111], v[80:83], v[68:71], v[108:111]
    s_add_u32 m0, s65, 6144
    ds_read_b64_tr_b16 v[40:41], v22 offset:0
    v_mfma_f32_16x16x32_bf16 v[112:115], v[84:87], v[68:71], v[112:115]
    buffer_load_dwordx4 v19, s[32:35], s69 offen  lds
    s_add_u32 s66, s66, 40960
    s_cmp_eq_u32 s66, 163840
    s_cselect_b32 s66, 0, s66
    s_add_u32 s64, s66, s27
    v_mfma_f32_16x16x32_bf16 v[116:119], v[88:91], v[68:71], v[116:119]
    s_add_u32 s65, s66, s3
    s_and_b32 s69, s8, 15
    s_lshr_b64 s[8:9], s[8:9], 4
    s_add_u32 s69, s69, s10
    v_mfma_f32_16x16x32_bf16 v[120:123], v[92:95], v[68:71], v[120:123]
    s_sub_u32 s68, s69, 9
    s_min_u32 s69, s69, s68
    s_mul_i32 s68, s69, 128
    s_mul_i32 s69, s69, 221184
    v_mfma_f32_16x16x32_bf16 v[124:127], v[96:99], v[68:71], v[124:127]
    s_add_u32 m0, s64, 0
    ds_read_b64_tr_b16 v[42:43], v22 offset:432
    v_mfma_f32_16x16x32_bf16 v[128:131], v[68:71], v[100:103], v[128:131]
    buffer_load_dwordx4 v10, s[28:31], s68 offen  lds
    ds_read_b128 v[28:31], v20 offset:0
    v_mfma_f32_16x16x32_bf16 v[132:135], v[68:71], v[104:107], v[132:135]
    ds_read_b128 v[32:35], v20 offset:2048
    ds_read_b128 v[36:39], v20 offset:4096
    v_mfma_f32_16x16x32_bf16 v[136:139], v[80:83], v[72:75], v[136:139]
    ds_read_b64_tr_b16 v[44:45], v22 offset:40
    ds_read_b64_tr_b16 v[46:47], v22 offset:472
    v_mfma_f32_16x16x32_bf16 v[140:143], v[84:87], v[72:75], v[140:143]
    s_add_u32 m0, s64, 1024
    ds_read_b64_tr_b16 v[48:49], v22 offset:144
    v_mfma_f32_16x16x32_bf16 v[144:147], v[88:91], v[72:75], v[144:147]
    buffer_load_dwordx4 v11, s[28:31], s68 offen  lds
    ds_read_b64_tr_b16 v[50:51], v22 offset:576
    v_mfma_f32_16x16x32_bf16 v[148:151], v[92:95], v[72:75], v[148:151]
    ds_read_b64_tr_b16 v[52:53], v22 offset:184
    ds_read_b64_tr_b16 v[54:55], v22 offset:616
    v_mfma_f32_16x16x32_bf16 v[152:155], v[96:99], v[72:75], v[152:155]
    ds_read_b64_tr_b16 v[56:57], v23 offset:0
    ds_read_b64_tr_b16 v[58:59], v23 offset:432
    v_mfma_f32_16x16x32_bf16 v[156:159], v[72:75], v[100:103], v[156:159]
    s_add_u32 m0, s64, 2048
    ds_read_b64_tr_b16 v[60:61], v22 offset:288
    v_mfma_f32_16x16x32_bf16 v[160:163], v[72:75], v[104:107], v[160:163]
    buffer_load_dwordx4 v12, s[28:31], s68 offen  lds
    ds_read_b64_tr_b16 v[62:63], v22 offset:720
    v_mfma_f32_16x16x32_bf16 v[164:167], v[80:83], v[76:79], v[164:167]
    ds_read_b64_tr_b16 v[64:65], v22 offset:328
    ds_read_b64_tr_b16 v[66:67], v22 offset:760
    v_mfma_f32_16x16x32_bf16 v[168:171], v[84:87], v[76:79], v[168:171]
    v_mfma_f32_16x16x32_bf16 v[172:175], v[88:91], v[76:79], v[172:175]
    s_add_u32 m0, s65, 0
    v_mfma_f32_16x16x32_bf16 v[176:179], v[92:95], v[76:79], v[176:179]
    buffer_load_dwordx4 v13, s[32:35], s69 offen  lds
    v_mfma_f32_16x16x32_bf16 v[180:183], v[96:99], v[76:79], v[180:183]
    v_mfma_f32_16x16x32_bf16 v[184:187], v[76:79], v[100:103], v[184:187]
    v_mfma_f32_16x16x32_bf16 v[188:191], v[76:79], v[104:107], v[188:191]
    s_sub_u32 s26, s26, 1
    s_cmp_lg_u32 s26, 0
    s_cbranch_scc1 L_loop_1
    s_waitcnt lgkmcnt(0)
    v_mfma_f32_16x16x32_bf16 v[108:111], v[40:43], v[28:31], v[108:111]
    s_add_u32 m0, s65, 1024
    ds_read_b64_tr_b16 v[80:81], v22 offset:14336
    v_mfma_f32_16x16x32_bf16 v[112:115], v[44:47], v[28:31], v[112:115]
    buffer_load_dwordx4 v14, s[32:35], s69 offen  lds
    ds_read_b64_tr_b16 v[82:83], v22 offset:14768
    v_mfma_f32_16x16x32_bf16 v[116:119], v[48:51], v[28:31], v[116:119]
    ds_read_b128 v[68:71], v21 offset:0
    ds_read_b128 v[72:75], v21 offset:2048
    v_mfma_f32_16x16x32_bf16 v[120:123], v[52:55], v[28:31], v[120:123]
    ds_read_b128 v[76:79], v21 offset:4096
    ds_read_b64_tr_b16 v[84:85], v22 offset:14376
    v_mfma_f32_16x16x32_bf16 v[124:127], v[56:59], v[28:31], v[124:127]
    s_add_u32 m0, s65, 2048
    ds_read_b64_tr_b16 v[86:87], v22 offset:14808
    v_mfma_f32_16x16x32_bf16 v[128:131], v[28:31], v[60:63], v[128:131]
    buffer_load_dwordx4 v15, s[32:35], s69 offen  lds
    ds_read_b64_tr_b16 v[88:89], v22 offset:14480
    v_mfma_f32_16x16x32_bf16 v[132:135], v[28:31], v[64:67], v[132:135]
    ds_read_b64_tr_b16 v[90:91], v22 offset:14912
    ds_read_b64_tr_b16 v[92:93], v22 offset:14520
    v_mfma_f32_16x16x32_bf16 v[136:139], v[40:43], v[32:35], v[136:139]
    ds_read_b64_tr_b16 v[94:95], v22 offset:14952
    ds_read_b64_tr_b16 v[96:97], v23 offset:14336
    v_mfma_f32_16x16x32_bf16 v[140:143], v[44:47], v[32:35], v[140:143]
    s_add_u32 m0, s65, 3072
    ds_read_b64_tr_b16 v[98:99], v23 offset:14768
    v_mfma_f32_16x16x32_bf16 v[144:147], v[48:51], v[32:35], v[144:147]
    buffer_load_dwordx4 v16, s[32:35], s69 offen  lds
    ds_read_b64_tr_b16 v[100:101], v22 offset:14624
    v_mfma_f32_16x16x32_bf16 v[148:151], v[52:55], v[32:35], v[148:151]
    ds_read_b64_tr_b16 v[102:103], v22 offset:15056
    ds_read_b64_tr_b16 v[104:105], v22 offset:14664
    v_mfma_f32_16x16x32_bf16 v[152:155], v[56:59], v[32:35], v[152:155]
    ds_read_b64_tr_b16 v[106:107], v22 offset:15096
    v_mfma_f32_16x16x32_bf16 v[156:159], v[32:35], v[60:63], v[156:159]
    s_add_u32 m0, s65, 4096
    v_mfma_f32_16x16x32_bf16 v[160:163], v[32:35], v[64:67], v[160:163]
    buffer_load_dwordx4 v17, s[32:35], s69 offen  lds
    v_mfma_f32_16x16x32_bf16 v[164:167], v[40:43], v[36:39], v[164:167]
    s_add_u32 s67, s67, 40960
    s_cmp_eq_u32 s67, 163840
    s_cselect_b32 s67, 0, s67
    v_mfma_f32_16x16x32_bf16 v[168:171], v[44:47], v[36:39], v[168:171]
    v_mfma_f32_16x16x32_bf16 v[172:175], v[48:51], v[36:39], v[172:175]
    s_add_u32 m0, s65, 5120
    v_mfma_f32_16x16x32_bf16 v[176:179], v[52:55], v[36:39], v[176:179]
    buffer_load_dwordx4 v18, s[32:35], s69 offen  lds
    v_mfma_f32_16x16x32_bf16 v[180:183], v[56:59], v[36:39], v[180:183]
    v_add_u32 v20, s67, v24
    v_add_u32 v21, s67, v25
    v_mfma_f32_16x16x32_bf16 v[184:187], v[36:39], v[60:63], v[184:187]
    v_add_u32 v22, s67, v26
    v_add_u32 v23, s67, v27
    v_mfma_f32_16x16x32_bf16 v[188:191], v[36:39], v[64:67], v[188:191]
    s_waitcnt vmcnt(9) lgkmcnt(0)
    s_barrier
    v_mfma_f32_16x16x32_bf16 v[108:111], v[80:83], v[68:71], v[108:111]
    s_add_u32 m0, s65, 6144
    ds_read_b64_tr_b16 v[40:41], v22 offset:0
    v_mfma_f32_16x16x32_bf16 v[112:115], v[84:87], v[68:71], v[112:115]
    buffer_load_dwordx4 v19, s[32:35], s69 offen  lds
    s_add_u32 s66, s66, 40960
    v_mfma_f32_16x16x32_bf16 v[116:119], v[88:91], v[68:71], v[116:119]
    s_cmp_eq_u32 s66, 163840
    ds_read_b64_tr_b16 v[42:43], v22 offset:432
    v_mfma_f32_16x16x32_bf16 v[120:123], v[92:95], v[68:71], v[120:123]
    ds_read_b128 v[28:31], v20 offset:0
    ds_read_b128 v[32:35], v20 offset:2048
    v_mfma_f32_16x16x32_bf16 v[124:127], v[96:99], v[68:71], v[124:127]
    s_cselect_b32 s66, 0, s66
    ds_read_b128 v[36:39], v20 offset:4096
    v_mfma_f32_16x16x32_bf16 v[128:131], v[68:71], v[100:103], v[128:131]
    ds_read_b64_tr_b16 v[44:45], v22 offset:40
    ds_read_b64_tr_b16 v[46:47], v22 offset:472
    v_mfma_f32_16x16x32_bf16 v[132:135], v[68:71], v[104:107], v[132:135]
    s_add_u32 s64, s66, s27
    ds_read_b64_tr_b16 v[48:49], v22 offset:144
    v_mfma_f32_16x16x32_bf16 v[136:139], v[80:83], v[72:75], v[136:139]
    s_add_u32 s65, s66, s3
    ds_read_b64_tr_b16 v[50:51], v22 offset:576
    v_mfma_f32_16x16x32_bf16 v[140:143], v[84:87], v[72:75], v[140:143]
    ds_read_b64_tr_b16 v[52:53], v22 offset:184
    ds_read_b64_tr_b16 v[54:55], v22 offset:616
    v_mfma_f32_16x16x32_bf16 v[144:147], v[88:91], v[72:75], v[144:147]
    s_and_b32 s69, s8, 15
    ds_read_b64_tr_b16 v[56:57], v23 offset:0
    v_mfma_f32_16x16x32_bf16 v[148:151], v[92:95], v[72:75], v[148:151]
    ds_read_b64_tr_b16 v[58:59], v23 offset:432
    ds_read_b64_tr_b16 v[60:61], v22 offset:288
    v_mfma_f32_16x16x32_bf16 v[152:155], v[96:99], v[72:75], v[152:155]
    s_lshr_b64 s[8:9], s[8:9], 4
    ds_read_b64_tr_b16 v[62:63], v22 offset:720
    v_mfma_f32_16x16x32_bf16 v[156:159], v[72:75], v[100:103], v[156:159]
    s_add_u32 s69, s69, s10
    ds_read_b64_tr_b16 v[64:65], v22 offset:328
    v_mfma_f32_16x16x32_bf16 v[160:163], v[72:75], v[104:107], v[160:163]
    ds_read_b64_tr_b16 v[66:67], v22 offset:760
    v_mfma_f32_16x16x32_bf16 v[164:167], v[80:83], v[76:79], v[164:167]
    s_sub_u32 s68, s69, 9
    v_mfma_f32_16x16x32_bf16 v[168:171], v[84:87], v[76:79], v[168:171]
    v_mfma_f32_16x16x32_bf16 v[172:175], v[88:91], v[76:79], v[172:175]
    s_min_u32 s69, s69, s68
    v_mfma_f32_16x16x32_bf16 v[176:179], v[92:95], v[76:79], v[176:179]
    s_mul_i32 s68, s69, 128
    v_mfma_f32_16x16x32_bf16 v[180:183], v[96:99], v[76:79], v[180:183]
    v_mfma_f32_16x16x32_bf16 v[184:187], v[76:79], v[100:103], v[184:187]
    s_mul_i32 s69, s69, 221184
    v_mfma_f32_16x16x32_bf16 v[188:191], v[76:79], v[104:107], v[188:191]
    s_waitcnt lgkmcnt(0)
    v_mfma_f32_16x16x32_bf16 v[108:111], v[40:43], v[28:31], v[108:111]
    s_add_u32 s98, s96, 0
    s_add_u32 m0, s27, 40960
    v_mfma_f32_16x16x32_bf16 v[112:115], v[44:47], v[28:31], v[112:115]
    buffer_load_dwordx4 v246, s[36:39], s98 offen lds
    ds_read_b64_tr_b16 v[80:81], v22 offset:14336
    v_mfma_f32_16x16x32_bf16 v[116:119], v[48:51], v[28:31], v[116:119]
    ds_read_b64_tr_b16 v[82:83], v22 offset:14768
    ds_read_b128 v[68:71], v21 offset:0
    v_mfma_f32_16x16x32_bf16 v[120:123], v[52:55], v[28:31], v[120:123]
    ds_read_b128 v[72:75], v21 offset:2048
    ds_read_b128 v[76:79], v21 offset:4096
    v_mfma_f32_16x16x32_bf16 v[124:127], v[56:59], v[28:31], v[124:127]
    ds_read_b64_tr_b16 v[84:85], v22 offset:14376
    ds_read_b64_tr_b16 v[86:87], v22 offset:14808
    v_mfma_f32_16x16x32_bf16 v[128:131], v[28:31], v[60:63], v[128:131]
    ds_read_b64_tr_b16 v[88:89], v22 offset:14480
    ds_read_b64_tr_b16 v[90:91], v22 offset:14912
    v_mfma_f32_16x16x32_bf16 v[132:135], v[28:31], v[64:67], v[132:135]
    ds_read_b64_tr_b16 v[92:93], v22 offset:14520
    ds_read_b64_tr_b16 v[94:95], v22 offset:14952
    v_mfma_f32_16x16x32_bf16 v[136:139], v[40:43], v[32:35], v[136:139]
    ds_read_b64_tr_b16 v[96:97], v23 offset:14336
    ds_read_b64_tr_b16 v[98:99], v23 offset:14768
    v_mfma_f32_16x16x32_bf16 v[140:143], v[44:47], v[32:35], v[140:143]
    ds_read_b64_tr_b16 v[100:101], v22 offset:14624
    ds_read_b64_tr_b16 v[102:103], v22 offset:15056
    v_mfma_f32_16x16x32_bf16 v[144:147], v[48:51], v[32:35], v[144:147]
    ds_read_b64_tr_b16 v[104:105], v22 offset:14664
    ds_read_b64_tr_b16 v[106:107], v22 offset:15096
    v_mfma_f32_16x16x32_bf16 v[148:151], v[52:55], v[32:35], v[148:151]
    s_add_u32 m0, s27, 41984
    v_mfma_f32_16x16x32_bf16 v[152:155], v[56:59], v[32:35], v[152:155]
    buffer_load_dwordx4 v247, s[36:39], s98 offen lds
    v_mfma_f32_16x16x32_bf16 v[156:159], v[32:35], v[60:63], v[156:159]
    v_mfma_f32_16x16x32_bf16 v[160:163], v[32:35], v[64:67], v[160:163]
    v_mfma_f32_16x16x32_bf16 v[164:167], v[40:43], v[36:39], v[164:167]
    s_add_u32 s67, s67, 40960
    s_cmp_eq_u32 s67, 163840
    s_cselect_b32 s67, 0, s67
    v_mfma_f32_16x16x32_bf16 v[168:171], v[44:47], v[36:39], v[168:171]
    v_mfma_f32_16x16x32_bf16 v[172:175], v[48:51], v[36:39], v[172:175]
    v_mfma_f32_16x16x32_bf16 v[176:179], v[52:55], v[36:39], v[176:179]
    v_mfma_f32_16x16x32_bf16 v[180:183], v[56:59], v[36:39], v[180:183]
    v_add_u32 v20, s67, v24
    v_add_u32 v21, s67, v25
    v_mfma_f32_16x16x32_bf16 v[184:187], v[36:39], v[60:63], v[184:187]
    v_add_u32 v22, s67, v26
    v_add_u32 v23, s67, v27
    v_mfma_f32_16x16x32_bf16 v[188:191], v[36:39], v[64:67], v[188:191]
    s_waitcnt vmcnt(2) lgkmcnt(0)
    s_barrier
    v_mfma_f32_16x16x32_bf16 v[108:111], v[80:83], v[68:71], v[108:111]
    s_add_u32 m0, s27, 43008
    ds_read_b64_tr_b16 v[40:41], v22 offset:0
    v_mfma_f32_16x16x32_bf16 v[112:115], v[84:87], v[68:71], v[112:115]
    buffer_load_dwordx4 v248, s[36:39], s98 offen lds
    ds_read_b64_tr_b16 v[42:43], v22 offset:432
    v_mfma_f32_16x16x32_bf16 v[116:119], v[88:91], v[68:71], v[116:119]
    ds_read_b128 v[28:31], v20 offset:0
    ds_read_b128 v[32:35], v20 offset:2048
    v_mfma_f32_16x16x32_bf16 v[120:123], v[92:95], v[68:71], v[120:123]
    ds_read_b128 v[36:39], v20 offset:4096
    ds_read_b64_tr_b16 v[44:45], v22 offset:40
    v_mfma_f32_16x16x32_bf16 v[124:127], v[96:99], v[68:71], v[124:127]
    ds_read_b64_tr_b16 v[46:47], v22 offset:472
    ds_read_b64_tr_b16 v[48:49], v22 offset:144
    v_mfma_f32_16x16x32_bf16 v[128:131], v[68:71], v[100:103], v[128:131]
    ds_read_b64_tr_b16 v[50:51], v22 offset:576
    ds_read_b64_tr_b16 v[52:53], v22 offset:184
    v_mfma_f32_16x16x32_bf16 v[132:135], v[68:71], v[104:107], v[132:135]
    ds_read_b64_tr_b16 v[54:55], v22 offset:616
    ds_read_b64_tr_b16 v[56:57], v23 offset:0
    v_mfma_f32_16x16x32_bf16 v[136:139], v[80:83], v[72:75], v[136:139]
    s_add_u32 s98, s96, 82944
    s_add_u32 m0, s27, 53248
    v_mfma_f32_16x16x32_bf16 v[140:143], v[84:87], v[72:75], v[140:143]
    buffer_load_dwordx4 v246, s[36:39], s98 offen lds
    ds_read_b64_tr_b16 v[58:59], v23 offset:432
    v_mfma_f32_16x16x32_bf16 v[144:147], v[88:91], v[72:75], v[144:147]
    ds_read_b64_tr_b16 v[60:61], v22 offset:288
    ds_read_b64_tr_b16 v[62:63], v22 offset:720
    v_mfma_f32_16x16x32_bf16 v[148:151], v[92:95], v[72:75], v[148:151]
    ds_read_b64_tr_b16 v[64:65], v22 offset:328
    ds_read_b64_tr_b16 v[66:67], v22 offset:760
    v_mfma_f32_16x16x32_bf16 v[152:155], v[96:99], v[72:75], v[152:155]
    v_mfma_f32_16x16x32_bf16 v[156:159], v[72:75], v[100:103], v[156:159]
    v_mfma_f32_16x16x32_bf16 v[160:163], v[72:75], v[104:107], v[160:163]
    v_mfma_f32_16x16x32_bf16 v[164:167], v[80:83], v[76:79], v[164:167]
    s_add_u32 m0, s27, 54272
    v_mfma_f32_16x16x32_bf16 v[168:171], v[84:87], v[76:79], v[168:171]
    buffer_load_dwordx4 v247, s[36:39], s98 offen lds
    v_mfma_f32_16x16x32_bf16 v[172:175], v[88:91], v[76:79], v[172:175]
    v_mfma_f32_16x16x32_bf16 v[176:179], v[92:95], v[76:79], v[176:179]
    v_mfma_f32_16x16x32_bf16 v[180:183], v[96:99], v[76:79], v[180:183]
    v_mfma_f32_16x16x32_bf16 v[184:187], v[76:79], v[100:103], v[184:187]
    v_mfma_f32_16x16x32_bf16 v[188:191], v[76:79], v[104:107], v[188:191]
    s_waitcnt lgkmcnt(0)
    v_mfma_f32_16x16x32_bf16 v[108:111], v[40:43], v[28:31], v[108:111]
    ds_read_b64_tr_b16 v[80:81], v22 offset:14336
    ds_read_b64_tr_b16 v[82:83], v22 offset:14768
    v_mfma_f32_16x16x32_bf16 v[112:115], v[44:47], v[28:31], v[112:115]
    buffer_load_dword v4, v255, s[52:55], 0 offen sc1
    ds_read_b128 v[68:71], v21 offset:0
    v_mfma_f32_16x16x32_bf16 v[116:119], v[48:51], v[28:31], v[116:119]
    ds_read_b128 v[72:75], v21 offset:2048
    ds_read_b128 v[76:79], v21 offset:4096
    v_mfma_f32_16x16x32_bf16 v[120:123], v[52:55], v[28:31], v[120:123]
    ds_read_b64_tr_b16 v[84:85], v22 offset:14376
    ds_read_b64_tr_b16 v[86:87], v22 offset:14808
    v_mfma_f32_16x16x32_bf16 v[124:127], v[56:59], v[28:31], v[124:127]
    ds_read_b64_tr_b16 v[88:89], v22 offset:14480
    ds_read_b64_tr_b16 v[90:91], v22 offset:14912
    v_mfma_f32_16x16x32_bf16 v[128:131], v[28:31], v[60:63], v[128:131]
    s_add_u32 m0, s27, 55296
    ds_read_b64_tr_b16 v[92:93], v22 offset:14520
    v_mfma_f32_16x16x32_bf16 v[132:135], v[28:31], v[64:67], v[132:135]
    buffer_load_dwordx4 v248, s[36:39], s98 offen lds
    ds_read_b64_tr_b16 v[94:95], v22 offset:14952
    v_mfma_f32_16x16x32_bf16 v[136:139], v[40:43], v[32:35], v[136:139]
    ds_read_b64_tr_b16 v[96:97], v23 offset:14336
    ds_read_b64_tr_b16 v[98:99], v23 offset:14768
    v_mfma_f32_16x16x32_bf16 v[140:143], v[44:47], v[32:35], v[140:143]
    ds_read_b64_tr_b16 v[100:101], v22 offset:14624
    ds_read_b64_tr_b16 v[102:103], v22 offset:15056
    v_mfma_f32_16x16x32_bf16 v[144:147], v[48:51], v[32:35], v[144:147]
    ds_read_b64_tr_b16 v[104:105], v22 offset:14664
    ds_read_b64_tr_b16 v[106:107], v22 offset:15096
    v_mfma_f32_16x16x32_bf16 v[148:151], v[52:55], v[32:35], v[148:151]
    s_add_u32 s98, s96, 165888
    s_add_u32 m0, s27, 65536
    v_mfma_f32_16x16x32_bf16 v[152:155], v[56:59], v[32:35], v[152:155]
    buffer_load_dwordx4 v246, s[36:39], s98 offen lds
    v_accvgpr_read_b32 v10, a0
    v_mfma_f32_16x16x32_bf16 v[156:159], v[32:35], v[60:63], v[156:159]
    v_accvgpr_read_b32 v11, a1
    v_accvgpr_read_b32 v12, a2
    v_mfma_f32_16x16x32_bf16 v[160:163], v[32:35], v[64:67], v[160:163]
    v_accvgpr_read_b32 v13, a3
    v_accvgpr_read_b32 v14, a4
    v_mfma_f32_16x16x32_bf16 v[164:167], v[40:43], v[36:39], v[164:167]
    v_accvgpr_read_b32 v15, a5
    v_accvgpr_read_b32 v16, a6
    v_mfma_f32_16x16x32_bf16 v[168:171], v[44:47], v[36:39], v[168:171]
    s_add_u32 m0, s27, 66560
    v_mfma_f32_16x16x32_bf16 v[172:175], v[48:51], v[36:39], v[172:175]
    buffer_load_dwordx4 v247, s[36:39], s98 offen lds
    v_mfma_f32_16x16x32_bf16 v[176:179], v[52:55], v[36:39], v[176:179]
    v_mfma_f32_16x16x32_bf16 v[180:183], v[56:59], v[36:39], v[180:183]
    v_mfma_f32_16x16x32_bf16 v[184:187], v[36:39], v[60:63], v[184:187]
    v_mfma_f32_16x16x32_bf16 v[188:191], v[36:39], v[64:67], v[188:191]
    s_mov_b32 s99, 0x3eae1a93
    s_add_u32 m0, s27, 67584
    s_waitcnt lgkmcnt(4)
    v_mfma_f32_16x16x32_bf16 v[180:183], v[96:99], v[76:79], v[180:183]
    buffer_load_dwordx4 v248, s[36:39], s98 offen lds
    s_add_u32 s98, s96, 248832
    s_add_u32 m0, s27, 77824
    v_mfma_f32_16x16x32_bf16 v[172:175], v[88:91], v[76:79], v[172:175]
    v_mfma_f32_16x16x32_bf16 v[176:179], v[92:95], v[76:79], v[176:179]
    s_waitcnt lgkmcnt(2)
    v_mfma_f32_16x16x32_bf16 v[184:187], v[76:79], v[100:103], v[184:187]
    s_waitcnt lgkmcnt(0)
    v_mfma_f32_16x16x32_bf16 v[188:191], v[76:79], v[104:107], v[188:191]
    buffer_load_dwordx4 v246, s[36:39], s98 offen lds
    s_add_u32 m0, s27, 78848
    v_mfma_f32_16x16x32_bf16 v[124:127], v[96:99], v[68:71], v[124:127]
    v_cvt_pk_bf16_f32 v49, v180, v181
    v_cvt_pk_bf16_f32 v48, v182, v183
    v_mfma_f32_16x16x32_bf16 v[152:155], v[96:99], v[72:75], v[152:155]
    v_cvt_pk_bf16_f32 v46, v172, v173
    v_cvt_pk_bf16_f32 v47, v174, v175
    v_mfma_f32_16x16x32_bf16 v[108:111], v[80:83], v[68:71], v[108:111]
    v_permlane16_swap_b32 v49, v48
    ds_write_b64 v252, v[46:47] offset:0
    v_mfma_f32_16x16x32_bf16 v[112:115], v[84:87], v[68:71], v[112:115]
    buffer_load_dwordx4 v247, s[36:39], s98 offen lds
    s_add_u32 m0, s27, 79872
    v_mfma_f32_16x16x32_bf16 v[180:183], v[46:49], v[228:231], v[232:235]
    v_cvt_pk_bf16_f32 v50, v176, v177
    v_cvt_pk_bf16_f32 v51, v178, v179
    v_mfma_f32_16x16x32_bf16 v[116:119], v[88:91], v[68:71], v[116:119]
    ds_write_b64 v252, v[48:49] offset:512
    v_cvt_pk_bf16_f32 v58, v184, v185
    v_mfma_f32_16x16x32_bf16 v[120:123], v[92:95], v[68:71], v[120:123]
    v_cvt_pk_bf16_f32 v59, v186, v187
    ds_write_b64 v252, v[50:51] offset:1024
    v_mfma_f32_16x16x32_bf16 v[144:147], v[88:91], v[72:75], v[144:147]
    buffer_load_dwordx4 v248, s[36:39], s98 offen lds
    s_add_u32 s98, s97, 0
    s_add_u32 m0, s27, 90112
    v_mfma_f32_16x16x32_bf16 v[148:151], v[92:95], v[72:75], v[148:151]
    v_cvt_pk_bf16_f32 v66, v188, v189
    v_cvt_pk_bf16_f32 v67, v190, v191
    v_mfma_f32_16x16x32_bf16 v[164:167], v[80:83], v[76:79], v[164:167]
    ds_write_b64 v252, v[58:59] offset:1536
    v_cvt_pk_bf16_f32 v26, v180, v181
    v_mfma_f32_16x16x32_bf16 v[168:171], v[84:87], v[76:79], v[168:171]
    v_cvt_pk_bf16_f32 v27, v182, v183
    ds_write_b64 v252, v[66:67] offset:2048
    v_mfma_f32_16x16x32_bf16 v[136:139], v[80:83], v[72:75], v[136:139]
    buffer_load_dwordx4 v246, s[36:39], s98 offen lds
    s_add_u32 m0, s27, 91136
    v_mfma_f32_16x16x32_bf16 v[140:143], v[84:87], v[72:75], v[140:143]
    ds_write_b64 v252, v[26:27] offset:2560
    v_cvt_pk_bf16_f32 v37, v124, v125
    v_mfma_f32_16x16x32_bf16 v[128:131], v[68:71], v[100:103], v[128:131]
    v_cvt_pk_bf16_f32 v36, v126, v127
    v_cvt_pk_bf16_f32 v43, v152, v153
    v_mfma_f32_16x16x32_bf16 v[132:135], v[68:71], v[104:107], v[132:135]
    v_cvt_pk_bf16_f32 v42, v154, v155
    v_permlane16_swap_b32 v37, v36
    v_mfma_f32_16x16x32_bf16 v[156:159], v[72:75], v[100:103], v[156:159]
    buffer_load_dwordx4 v247, s[36:39], s98 offen lds
    s_add_u32 m0, s27, 92160
    v_mfma_f32_16x16x32_bf16 v[160:163], v[72:75], v[104:107], v[160:163]
    s_waitcnt vmcnt(9)
    v_or_b32 v4, s11, v4
    v_cmp_ne_u32 s[12:13], -1, v4
    v_cvt_pk_bf16_f32 v208, v164, v165
    v_cvt_pk_bf16_f32 v209, v166, v167
    v_cvt_pk_bf16_f32 v214, v168, v169
    s_waitcnt lgkmcnt(0)
    s_cmp_lg_u64 s[12:13], 0
    s_cbranch_scc1 L_poll_2
L_pok_3:
    s_barrier
    ds_read_b64 v[28:29], v253 offset:0
    ds_read_b64 v[30:31], v253 offset:512
    ds_read_b64 v[32:33], v253 offset:1024
    v_cvt_pk_bf16_f32 v215, v170, v171
    v_and_b32 v210, v238, v49
    v_and_b32 v212, v239, v49
    v_cvt_pk_bf16_f32 v40, v144, v145
    buffer_load_dwordx4 v248, s[36:39], s98 offen lds
    s_add_u32 s98, s97, 82944
    s_add_u32 m0, s27, 102400
    v_mfma_f32_16x16x32_bf16 v[168:171], v[46:49], v[208:211], v[224:227]
    v_cvt_pk_bf16_f32 v41, v146, v147
    v_permlane16_swap_b32 v43, v42
    v_mfma_f32_16x16x32_bf16 v[176:179], v[48:51], v[212:215], v[224:227]
    v_cvt_pk_bf16_f32 v44, v148, v149
    v_cvt_pk_bf16_f32 v45, v150, v151
    v_mfma_f32_16x16x32_bf16 v[164:167], v[40:43], v[208:211], v[224:227]
    v_cvt_pk_bf16_f32 v34, v116, v117
    v_cvt_pk_bf16_f32 v35, v118, v119
    v_mfma_f32_16x16x32_bf16 v[172:175], v[42:45], v[212:215], v[224:227]
    buffer_load_dwordx4 v246, s[36:39], s98 offen lds
    s_add_u32 m0, s27, 103424
    v_mfma_f32_16x16x32_bf16 v[152:155], v[40:43], v[228:231], v[232:235]
    v_cvt_pk_bf16_f32 v38, v120, v121
    v_cvt_pk_bf16_f32 v39, v122, v123
    v_mfma_f32_16x16x32_bf16 v[124:127], v[34:37], v[228:231], v[232:235]
    v_cvt_pk_bf16_f32 v192, v108, v109
    v_cvt_pk_bf16_f32 v193, v110, v111
    v_cvt_pk_bf16_f32 v198, v112, v113
    v_cvt_pk_bf16_f32 v199, v114, v115
    v_and_b32 v194, v238, v37
    v_and_b32 v196, v239, v37
    v_cvt_pk_bf16_f32 v200, v136, v137
    s_waitcnt lgkmcnt(1)
    v_mfma_f32_16x16x32_bf16 v[108:111], v[28:31], v[192:195], v[216:219]
    buffer_load_dwordx4 v247, s[36:39], s98 offen lds
    s_add_u32 m0, s27, 104448
    v_mfma_f32_16x16x32_bf16 v[112:115], v[34:37], v[192:195], v[216:219]
    v_cvt_pk_bf16_f32 v201, v138, v139
    v_cvt_pk_bf16_f32 v206, v140, v141
    s_waitcnt lgkmcnt(0)
    v_mfma_f32_16x16x32_bf16 v[116:119], v[30:33], v[196:199], v[216:219]
    v_cvt_pk_bf16_f32 v207, v142, v143
    v_and_b32 v202, v238, v43
    v_mfma_f32_16x16x32_bf16 v[120:123], v[36:39], v[196:199], v[216:219]
    v_and_b32 v204, v239, v43
    ds_read_b64 v[52:53], v253 offset:1536
    v_mfma_f32_16x16x32_bf16 v[136:139], v[34:37], v[200:203], v[220:223]
    buffer_load_dwordx4 v248, s[36:39], s98 offen lds
    s_add_u32 s98, s97, 165888
    s_add_u32 m0, s27, 114688
    v_mfma_f32_16x16x32_bf16 v[140:143], v[40:43], v[200:203], v[220:223]
    ds_read_b64 v[60:61], v253 offset:2048
    ds_read_b64 v[20:21], v253 offset:2560
    v_mfma_f32_16x16x32_bf16 v[144:147], v[36:39], v[204:207], v[220:223]
    v_cndmask_b32 v168, v168, v164, s[70:71]
    v_cndmask_b32 v169, v169, v165, s[72:73]
    v_mfma_f32_16x16x32_bf16 v[148:151], v[42:45], v[204:207], v[220:223]
    v_cndmask_b32 v170, v170, v166, s[74:75]
    v_cndmask_b32 v176, v176, v172, s[70:71]
    v_cndmask_b32 v177, v177, v173, s[72:73]
    buffer_load_dwordx4 v246, s[36:39], s98 offen lds
    s_add_u32 m0, s27, 115712
    v_cndmask_b32 v178, v178, v174, s[74:75]
    v_cndmask_b32 v112, v112, v108, s[70:71]
    v_cndmask_b32 v113, v113, v109, s[72:73]
    v_cndmask_b32 v114, v114, v110, s[74:75]
    v_cndmask_b32 v120, v120, v116, s[70:71]
    v_cndmask_b32 v121, v121, v117, s[72:73]
    v_cndmask_b32 v122, v122, v118, s[74:75]
    v_cndmask_b32 v171, v171, v167, s[76:77]
    v_max3_f32 v164, v168, v169, v170
    v_cndmask_b32 v179, v179, v175, s[76:77]
    v_max3_f32 v172, v176, v177, v178
    v_cndmask_b32 v140, v140, v136, s[70:71]
    v_cndmask_b32 v141, v141, v137, s[72:73]
    v_cndmask_b32 v142, v142, v138, s[74:75]
    buffer_load_dwordx4 v247, s[36:39], s98 offen lds
    s_add_u32 m0, s27, 116736
    v_cndmask_b32 v148, v148, v144, s[70:71]
    v_cndmask_b32 v149, v149, v145, s[72:73]
    v_cndmask_b32 v150, v150, v146, s[74:75]
    v_cndmask_b32 v115, v115, v111, s[76:77]
    v_max3_f32 v108, v112, v113, v114
    v_cndmask_b32 v123, v123, v119, s[76:77]
    v_max3_f32 v116, v120, v121, v122
    v_max_f32 v164, v164, v171
    v_max_f32 v172, v172, v179
    v_cndmask_b32 v143, v143, v139, s[76:77]
    v_max3_f32 v136, v140, v141, v142
    v_cndmask_b32 v151, v151, v147, s[76:77]
    v_max3_f32 v144, v148, v149, v150
    v_max_f32 v108, v108, v115
    buffer_load_dwordx4 v248, s[36:39], s98 offen lds
    s_add_u32 s98, s97, 248832
    s_add_u32 m0, s27, 126976
    v_max_f32 v116, v116, v123
    v_max_f32 v136, v136, v143
    v_max_f32 v144, v144, v151
    v_permlane32_swap_b32 v164, v172
    v_permlane32_swap_b32 v108, v116
    v_max_f32 v165, v164, v172
    v_max_f32 v173, v164, v172
    v_permlane32_swap_b32 v136, v144
    v_max_f32 v109, v108, v116
    v_max_f32 v117, v108, v116
    v_max_f32 v137, v136, v144
    v_max_f32 v145, v136, v144
    v_permlane16_swap_b32 v165, v173
    buffer_load_dwordx4 v246, s[36:39], s98 offen lds
    s_add_u32 m0, s27, 128000
    v_permlane16_swap_b32 v109, v117
    v_max_f32 v165, v165, v173
    v_permlane16_swap_b32 v137, v145
    v_max_f32 v109, v109, v117
    v_mul_f32 v164, s99, v165
    v_mul_f32 v172, s99, v165
    v_max_f32 v137, v137, v145
    v_mul_f32 v108, s99, v109
    v_mul_f32 v116, s99, v109
    v_mul_f32 v136, s99, v137
    v_mul_f32 v144, s99, v137
    v_permlane32_swap_b32 v164, v172
    v_permlane32_swap_b32 v108, v116
    v_fma_f32 v168, v168, s99, -v164
    buffer_load_dwordx4 v247, s[36:39], s98 offen lds
    s_add_u32 m0, s27, 129024
    v_fma_f32 v169, v169, s99, -v164
    v_fma_f32 v170, v170, s99, -v164
    v_fma_f32 v171, v171, s99, -v164
    v_fma_f32 v176, v176, s99, -v172
    v_fma_f32 v177, v177, s99, -v172
    v_fma_f32 v178, v178, s99, -v172
    v_fma_f32 v179, v179, s99, -v172
    v_permlane32_swap_b32 v136, v144
    v_fma_f32 v112, v112, s99, -v108
    v_fma_f32 v113, v113, s99, -v108
    v_fma_f32 v114, v114, s99, -v108
    v_fma_f32 v115, v115, s99, -v108
    v_fma_f32 v120, v120, s99, -v116
    v_fma_f32 v121, v121, s99, -v116
    buffer_load_dwordx4 v248, s[36:39], s98 offen lds
    s_mov_b32 s98, 0
    s_add_u32 m0, s27, 139264
    v_fma_f32 v122, v122, s99, -v116
    v_fma_f32 v123, v123, s99, -v116
    v_exp_f32 v168, v168
    v_exp_f32 v169, v169
    v_exp_f32 v170, v170
    v_exp_f32 v171, v171
    v_exp_f32 v176, v176
    v_exp_f32 v177, v177
    buffer_load_dwordx4 v249, s[36:39], s98 offen lds
    s_add_u32 m0, s27, 140288
    v_exp_f32 v178, v178
    v_exp_f32 v179, v179
    v_fma_f32 v140, v140, s99, -v136
    v_fma_f32 v141, v141, s99, -v136
    v_fma_f32 v142, v142, s99, -v136
    v_fma_f32 v143, v143, s99, -v136
    v_fma_f32 v148, v148, s99, -v144
    v_fma_f32 v149, v149, s99, -v144
    v_fma_f32 v150, v150, s99, -v144
    v_fma_f32 v151, v151, s99, -v144
    v_exp_f32 v112, v112
    buffer_load_dwordx4 v250, s[36:39], s98 offen lds
    s_add_u32 m0, s27, 141312
    v_exp_f32 v113, v113
    v_exp_f32 v114, v114
    v_exp_f32 v115, v115
    v_exp_f32 v120, v120
    v_exp_f32 v121, v121
    v_exp_f32 v122, v122
    v_exp_f32 v123, v123
    buffer_load_dwordx4 v251, s[36:39], s98 offen lds
    v_exp_f32 v140, v140
    v_exp_f32 v141, v141
    v_exp_f32 v142, v142
    v_exp_f32 v143, v143
    v_exp_f32 v148, v148
    v_exp_f32 v149, v149
    v_exp_f32 v150, v150
    v_exp_f32 v151, v151
    v_cvt_pk_bf16_f32 v54, v128, v129
    v_cvt_pk_bf16_f32 v62, v132, v133
    v_cvt_pk_bf16_f32 v164, v168, v169
    v_cvt_pk_bf16_f32 v165, v170, v171
    v_cvt_pk_bf16_f32 v172, v176, v177
    v_cvt_pk_bf16_f32 v173, v178, v179
    v_cvt_pk_bf16_f32 v108, v112, v113
    v_cvt_pk_bf16_f32 v109, v114, v115
    v_cvt_pk_bf16_f32 v116, v120, v121
    v_cvt_pk_bf16_f32 v117, v122, v123
    v_cvt_pk_bf16_f32 v56, v156, v157
    v_cvt_pk_bf16_f32 v64, v160, v161
    v_cvt_pk_bf16_f32 v55, v130, v131
    v_cvt_pk_bf16_f32 v63, v134, v135
    v_and_b32 v184, v236, v164
    v_and_b32 v185, v237, v165
    v_and_b32 v188, v236, v172
    v_and_b32 v189, v237, v173
    v_cvt_pk_bf16_f32 v136, v140, v141
    v_cvt_pk_bf16_f32 v137, v142, v143
    v_cvt_pk_bf16_f32 v144, v148, v149
    v_cvt_pk_bf16_f32 v145, v150, v151
    v_and_b32 v128, v236, v108
    v_and_b32 v129, v237, v109
    v_and_b32 v132, v236, v116
    v_and_b32 v133, v237, v117
    v_cvt_pk_bf16_f32 v57, v158, v159
    v_cvt_pk_bf16_f32 v65, v162, v163
    v_cvt_pk_bf16_f32 v24, v152, v153
    v_cvt_pk_bf16_f32 v25, v154, v155
    v_cvt_pk_bf16_f32 v22, v124, v125
    v_cvt_pk_bf16_f32 v23, v126, v127
    v_xor_b32 v186, v184, v164
    v_xor_b32 v187, v185, v165
    v_xor_b32 v190, v188, v172
    v_xor_b32 v191, v189, v173
    v_mfma_f32_16x16x32_bf16 v[168:171], v[24:27], v[184:187], 0
    v_and_b32 v156, v236, v136
    v_and_b32 v157, v237, v137
    v_mfma_f32_16x16x32_bf16 v[176:179], v[24:27], v[188:191], 0
    v_and_b32 v160, v236, v144
    v_and_b32 v161, v237, v145
    v_mfma_f32_16x16x32_bf16 v[164:167], v[56:59], v[184:187], 0
    v_xor_b32 v130, v128, v108
    v_xor_b32 v131, v129, v109
    v_mfma_f32_16x16x32_bf16 v[172:175], v[64:67], v[188:191], 0
    v_xor_b32 v134, v132, v116
    v_xor_b32 v135, v133, v117
    s_waitcnt lgkmcnt(0)
    v_mfma_f32_16x16x32_bf16 v[112:115], v[20:23], v[128:131], 0
    v_xor_b32 v158, v156, v136
    v_xor_b32 v159, v157, v137
    v_mfma_f32_16x16x32_bf16 v[120:123], v[20:23], v[132:135], 0
    v_xor_b32 v162, v160, v144
    v_xor_b32 v163, v161, v145
    v_mfma_f32_16x16x32_bf16 v[140:143], v[22:25], v[156:159], 0
    v_rcp_f32 v171, v170
    v_mfma_f32_16x16x32_bf16 v[148:151], v[22:25], v[160:163], 0
    v_rcp_f32 v179, v178
    v_mfma_f32_16x16x32_bf16 v[136:139], v[54:57], v[156:159], 0
    v_rcp_f32 v115, v114
    v_mfma_f32_16x16x32_bf16 v[144:147], v[62:65], v[160:163], 0
    v_rcp_f32 v123, v122
    v_mfma_f32_16x16x32_bf16 v[108:111], v[52:55], v[128:131], 0
    v_rcp_f32 v143, v142
    v_mfma_f32_16x16x32_bf16 v[116:119], v[60:63], v[132:135], 0
    v_rcp_f32 v151, v150
    v_cndmask_b32 v168, v176, v168, s[78:79]
    v_cndmask_b32 v169, v177, v169, s[78:79]
    v_cndmask_b32 v170, v179, v171, s[78:79]
    v_cndmask_b32 v112, v120, v112, s[78:79]
    v_cndmask_b32 v113, v121, v113, s[78:79]
    v_cndmask_b32 v114, v123, v115, s[78:79]
    v_mul_f32 v168, v168, v170
    v_mul_f32 v169, v169, v170
    v_cndmask_b32 v140, v148, v140, s[78:79]
    v_cndmask_b32 v141, v149, v141, s[78:79]
    v_cndmask_b32 v142, v151, v143, s[78:79]
    v_mul_f32 v112, v112, v114
    v_mul_f32 v113, v113, v114
    s_mov_b32 vcc_lo, -1
    v_mul_f32 v166, v166, v171
    v_mul_f32 v167, v167, v171
    v_mul_f32 v174, v174, v179
    v_mul_f32 v175, v175, v179
    v_cvt_pk_bf16_f32 v5, v168, v169
    v_mul_f32 v140, v140, v142
    v_mul_f32 v141, v141, v142
    v_cvt_pk_bf16_f32 v6, v112, v113
    s_mov_b32 vcc_hi, 0
    v_mul_f32 v164, v164, v171
    v_mul_f32 v165, v165, v171
    v_cvt_pk_bf16_f32 v181, v166, v167
    v_mul_f32 v172, v172, v179
    v_mul_f32 v173, v173, v179
    v_cvt_pk_bf16_f32 v183, v174, v175
    v_mul_f32 v138, v138, v143
    v_mul_f32 v139, v139, v143
    v_mul_f32 v146, v146, v151
    v_mul_f32 v147, v147, v151
    v_cvt_pk_bf16_f32 v7, v140, v141
    v_cndmask_b32 v6, v5, v6, vcc
    v_cvt_pk_bf16_f32 v180, v164, v165
    v_min_u32 v181, -2, v181
    v_cvt_pk_bf16_f32 v182, v172, v173
    v_min_u32 v183, -2, v183
    v_mul_f32 v136, v136, v143
    v_mul_f32 v137, v137, v143
    v_cvt_pk_bf16_f32 v153, v138, v139
    v_mul_f32 v144, v144, v151
    v_mul_f32 v145, v145, v151
    v_cvt_pk_bf16_f32 v155, v146, v147
    v_mul_f32 v110, v110, v115
    v_mul_f32 v111, v111, v115
    v_mul_f32 v118, v118, v123
    v_mul_f32 v119, v119, v123
    buffer_store_dwordx4 v[180:183], v242, s[44:47], 0 offen sc1
    v_cvt_pk_bf16_f32 v152, v136, v137
    v_min_u32 v153, -2, v153
    v_cvt_pk_bf16_f32 v154, v144, v145
    v_min_u32 v155, -2, v155
    v_mul_f32 v108, v108, v115
    v_mul_f32 v109, v109, v115
    v_cvt_pk_bf16_f32 v125, v110, v111
    v_mul_f32 v116, v116, v123
    v_mul_f32 v117, v117, v123
    v_cvt_pk_bf16_f32 v127, v118, v119
    buffer_store_dwordx4 v[152:155], v241, s[44:47], 0 offen sc1
    v_cvt_pk_bf16_f32 v124, v108, v109
    v_min_u32 v125, -2, v125
    v_cvt_pk_bf16_f32 v126, v116, v117
    v_min_u32 v127, -2, v127
    v_permlane16_swap_b32 v6, v7
    buffer_store_dwordx4 v[124:127], v240, s[44:47], 0 offen sc1
    v_min_u32 v7, -2, v7
    buffer_store_dwordx2 v[6:7], v243, s[44:47], 0 offen sc1
    s_lshl_b32 s70, s57, 13
    s_and_b32 s70, s70, 8192
    s_add_u32 s71, s70, 4096
    s_xor_b32 s72, s70, 8192
    s_xor_b32 s73, s71, 8192
    s_mov_b32 s26, 65536
    s_waitcnt vmcnt(4)
    s_barrier
    ds_read_b64_tr_b16 a[0:1], v10 offset:0
    ds_read_b64_tr_b16 a[2:3], v10 offset:768
    ds_read_b64_tr_b16 a[4:5], v11 offset:32
    ds_read_b64_tr_b16 a[6:7], v11 offset:800
    ds_read_b64_tr_b16 a[8:9], v10 offset:64
    ds_read_b64_tr_b16 a[10:11], v10 offset:832
    ds_read_b64_tr_b16 a[12:13], v11 offset:96
    ds_read_b64_tr_b16 a[14:15], v11 offset:864
    ds_read_b64_tr_b16 a[16:17], v10 offset:128
    ds_read_b64_tr_b16 a[18:19], v10 offset:896
    ds_read_b64_tr_b16 a[20:21], v11 offset:160
    ds_read_b64_tr_b16 a[22:23], v11 offset:928
    ds_read_b64_tr_b16 a[24:25], v10 offset:6144
    ds_read_b64_tr_b16 a[26:27], v10 offset:6912
    ds_read_b64_tr_b16 a[28:29], v11 offset:6176
    ds_read_b64_tr_b16 a[30:31], v11 offset:6944
    ds_read_b64_tr_b16 a[32:33], v10 offset:6208
    ds_read_b64_tr_b16 a[34:35], v10 offset:6976
    ds_read_b64_tr_b16 a[36:37], v11 offset:6240
    ds_read_b64_tr_b16 a[38:39], v11 offset:7008
    ds_read_b64_tr_b16 a[40:41], v10 offset:6272
    ds_read_b64_tr_b16 a[42:43], v10 offset:7040
    ds_read_b64_tr_b16 a[44:45], v11 offset:6304
    ds_read_b64_tr_b16 a[46:47], v11 offset:7072
    ds_read_b64_tr_b16 a[48:49], v10 offset:12288
    ds_read_b64_tr_b16 a[50:51], v10 offset:13056
    ds_read_b64_tr_b16 a[52:53], v11 offset:12320
    ds_read_b64_tr_b16 a[54:55], v11 offset:13088
    ds_read_b64_tr_b16 a[56:57], v10 offset:12352
    ds_read_b64_tr_b16 a[58:59], v10 offset:13120
    ds_read_b64_tr_b16 a[60:61], v11 offset:12384
    ds_read_b64_tr_b16 a[62:63], v11 offset:13152
    ds_read_b64_tr_b16 a[64:65], v10 offset:12416
    ds_read_b64_tr_b16 a[66:67], v10 offset:13184
    ds_read_b64_tr_b16 a[68:69], v11 offset:12448
    ds_read_b64_tr_b16 a[70:71], v11 offset:13216
    ds_read_b64_tr_b16 a[72:73], v10 offset:18432
    ds_read_b64_tr_b16 a[74:75], v10 offset:19200
    ds_read_b64_tr_b16 a[76:77], v11 offset:18464
    ds_read_b64_tr_b16 a[78:79], v11 offset:19232
    ds_read_b64_tr_b16 a[80:81], v10 offset:18496
    ds_read_b64_tr_b16 a[82:83], v10 offset:19264
    ds_read_b64_tr_b16 a[84:85], v11 offset:18528
    ds_read_b64_tr_b16 a[86:87], v11 offset:19296
    ds_read_b64_tr_b16 a[88:89], v10 offset:18560
    ds_read_b64_tr_b16 a[90:91], v10 offset:19328
    ds_read_b64_tr_b16 a[92:93], v11 offset:18592
    ds_read_b64_tr_b16 a[94:95], v11 offset:19360
    ds_read_b64_tr_b16 a[96:97], v10 offset:24576
    ds_read_b64_tr_b16 a[98:99], v10 offset:25344
    ds_read_b64_tr_b16 a[100:101], v11 offset:24608
    ds_read_b64_tr_b16 a[102:103], v11 offset:25376
    ds_read_b64_tr_b16 a[104:105], v10 offset:24640
    ds_read_b64_tr_b16 a[106:107], v10 offset:25408
    ds_read_b64_tr_b16 a[108:109], v11 offset:24672
    ds_read_b64_tr_b16 a[110:111], v11 offset:25440
    ds_read_b64_tr_b16 a[112:113], v10 offset:24704
    ds_read_b64_tr_b16 a[114:115], v10 offset:25472
    ds_read_b64_tr_b16 a[116:117], v11 offset:24736
    ds_read_b64_tr_b16 a[118:119], v11 offset:25504
    ds_read_b64_tr_b16 a[120:121], v10 offset:30720
    ds_read_b64_tr_b16 a[122:123], v10 offset:31488
    ds_read_b64_tr_b16 a[124:125], v11 offset:30752
    ds_read_b64_tr_b16 a[126:127], v11 offset:31520
    ds_read_b64_tr_b16 a[128:129], v10 offset:30784
    ds_read_b64_tr_b16 a[130:131], v10 offset:31552
    ds_read_b64_tr_b16 a[132:133], v11 offset:30816
    ds_read_b64_tr_b16 a[134:135], v11 offset:31584
    ds_read_b64_tr_b16 a[136:137], v10 offset:30848
    ds_read_b64_tr_b16 a[138:139], v10 offset:31616
    ds_read_b64_tr_b16 a[140:141], v11 offset:30880
    ds_read_b64_tr_b16 a[142:143], v11 offset:31648
    ds_read_b64_tr_b16 a[144:145], v10 offset:36864
    ds_read_b64_tr_b16 a[146:147], v10 offset:37632
    ds_read_b64_tr_b16 a[148:149], v11 offset:36896
    ds_read_b64_tr_b16 a[150:151], v11 offset:37664
    ds_read_b64_tr_b16 a[152:153], v10 offset:36928
    ds_read_b64_tr_b16 a[154:155], v10 offset:37696
    ds_read_b64_tr_b16 a[156:157], v11 offset:36960
    ds_read_b64_tr_b16 a[158:159], v11 offset:37728
    ds_read_b64_tr_b16 a[160:161], v10 offset:36992
    ds_read_b64_tr_b16 a[162:163], v10 offset:37760
    ds_read_b64_tr_b16 a[164:165], v11 offset:37024
    ds_read_b64_tr_b16 a[166:167], v11 offset:37792
    ds_read_b64_tr_b16 a[168:169], v10 offset:43008
    ds_read_b64_tr_b16 a[170:171], v10 offset:43776
    ds_read_b64_tr_b16 a[172:173], v11 offset:43040
    ds_read_b64_tr_b16 a[174:175], v11 offset:43808
    ds_read_b64_tr_b16 a[176:177], v10 offset:43072
    ds_read_b64_tr_b16 a[178:179], v10 offset:43840
    ds_read_b64_tr_b16 a[180:181], v11 offset:43104
    ds_read_b64_tr_b16 a[182:183], v11 offset:43872
    ds_read_b64_tr_b16 a[184:185], v10 offset:43136
    ds_read_b64_tr_b16 a[186:187], v10 offset:43904
    ds_read_b64_tr_b16 a[188:189], v11 offset:43168
    ds_read_b64_tr_b16 a[190:191], v11 offset:43936
    ds_read_b64_tr_b16 a[192:193], v10 offset:49152
    ds_read_b64_tr_b16 a[194:195], v10 offset:49920
    ds_read_b64_tr_b16 a[196:197], v11 offset:49184
    ds_read_b64_tr_b16 a[198:199], v11 offset:49952
    ds_read_b64_tr_b16 a[200:201], v10 offset:49216
    ds_read_b64_tr_b16 a[202:203], v10 offset:49984
    ds_read_b64_tr_b16 a[204:205], v11 offset:49248
    ds_read_b64_tr_b16 a[206:207], v11 offset:50016
    ds_read_b64_tr_b16 a[208:209], v10 offset:49280
    ds_read_b64_tr_b16 a[210:211], v10 offset:50048
    ds_read_b64_tr_b16 a[212:213], v11 offset:49312
    ds_read_b64_tr_b16 a[214:215], v11 offset:50080
    ds_read_b64_tr_b16 a[216:217], v10 offset:55296
    ds_read_b64_tr_b16 a[218:219], v10 offset:56064
    ds_read_b64_tr_b16 a[220:221], v11 offset:55328
    ds_read_b64_tr_b16 a[222:223], v11 offset:56096
    ds_read_b64_tr_b16 a[224:225], v10 offset:55360
    ds_read_b64_tr_b16 a[226:227], v10 offset:56128
    ds_read_b64_tr_b16 a[228:229], v11 offset:55392
    ds_read_b64_tr_b16 a[230:231], v11 offset:56160
    ds_read_b64_tr_b16 a[232:233], v10 offset:55424
    ds_read_b64_tr_b16 a[234:235], v10 offset:56192
    ds_read_b64_tr_b16 a[236:237], v11 offset:55456
    ds_read_b64_tr_b16 a[238:239], v11 offset:56224
    ds_read_b64_tr_b16 v[124:125], v12 offset:0
    ds_read_b64_tr_b16 v[126:127], v12 offset:768
    ds_read_b64_tr_b16 v[128:129], v13 offset:32
    ds_read_b64_tr_b16 v[130:131], v13 offset:800
    ds_read_b64_tr_b16 v[132:133], v12 offset:64
    ds_read_b64_tr_b16 v[134:135], v12 offset:832
    ds_read_b64_tr_b16 v[136:137], v13 offset:96
    ds_read_b64_tr_b16 v[138:139], v13 offset:864
    ds_read_b64_tr_b16 v[140:141], v12 offset:128
    ds_read_b64_tr_b16 v[142:143], v12 offset:896
    ds_read_b64_tr_b16 v[144:145], v13 offset:160
    ds_read_b64_tr_b16 v[146:147], v13 offset:928
    ds_read_b64_tr_b16 v[148:149], v12 offset:6144
    ds_read_b64_tr_b16 v[150:151], v12 offset:6912
    ds_read_b64_tr_b16 v[152:153], v13 offset:6176
    ds_read_b64_tr_b16 v[154:155], v13 offset:6944
    ds_read_b64_tr_b16 v[156:157], v12 offset:6208
    ds_read_b64_tr_b16 v[158:159], v12 offset:6976
    ds_read_b64_tr_b16 v[160:161], v13 offset:6240
    ds_read_b64_tr_b16 v[162:163], v13 offset:7008
    ds_read_b64_tr_b16 v[164:165], v12 offset:6272
    buffer_load_dwordx4 v[28:31], v14, s[44:47], s70 offen offset:0 sc1
    ds_read_b64_tr_b16 v[166:167], v12 offset:7040
    ds_read_b64_tr_b16 v[168:169], v13 offset:6304
    buffer_load_dwordx4 v[32:35], v14, s[44:47], s70 offen offset:1024 sc1
    ds_read_b64_tr_b16 v[170:171], v13 offset:7072
    ds_read_b64_tr_b16 v[172:173], v12 offset:12288
    ds_read_b64_tr_b16 v[174:175], v12 offset:13056
    buffer_load_dwordx4 v[36:39], v14, s[44:47], s70 offen offset:2048 sc1
    ds_read_b64_tr_b16 v[176:177], v13 offset:12320
    ds_read_b64_tr_b16 v[178:179], v13 offset:13088
    ds_read_b64_tr_b16 v[180:181], v12 offset:12352
    buffer_load_dwordx4 v[40:43], v14, s[44:47], s70 offen offset:3072 sc1
    ds_read_b64_tr_b16 v[182:183], v12 offset:13120
    ds_read_b64_tr_b16 v[184:185], v13 offset:12384
    buffer_load_dwordx4 v[44:47], v14, s[44:47], s71 offen offset:0 sc1
    ds_read_b64_tr_b16 v[186:187], v13 offset:13152
    ds_read_b64_tr_b16 v[188:189], v12 offset:12416
    ds_read_b64_tr_b16 v[190:191], v12 offset:13184
    buffer_load_dwordx4 v[48:51], v14, s[44:47], s71 offen offset:1024 sc1
    ds_read_b64_tr_b16 v[192:193], v13 offset:12448
    ds_read_b64_tr_b16 v[194:195], v13 offset:13216
    ds_read_b64_tr_b16 v[196:197], v12 offset:18432
    ds_read_b64_tr_b16 v[198:199], v12 offset:19200
    ds_read_b64_tr_b16 v[200:201], v13 offset:18464
    ds_read_b64_tr_b16 v[202:203], v13 offset:19232
    ds_read_b64_tr_b16 v[204:205], v12 offset:18496
    ds_read_b64_tr_b16 v[206:207], v12 offset:19264
    ds_read_b64_tr_b16 v[208:209], v13 offset:18528
    ds_read_b64_tr_b16 v[210:211], v13 offset:19296
    ds_read_b64_tr_b16 v[212:213], v12 offset:18560
    ds_read_b64_tr_b16 v[214:215], v12 offset:19328
    ds_read_b64_tr_b16 v[216:217], v13 offset:18592
    ds_read_b64_tr_b16 v[218:219], v13 offset:19360
    ds_read_b64_tr_b16 v[220:221], v12 offset:24576
    ds_read_b64_tr_b16 v[222:223], v12 offset:25344
    ds_read_b64_tr_b16 v[224:225], v13 offset:24608
    ds_read_b64_tr_b16 v[226:227], v13 offset:25376
    ds_read_b64_tr_b16 v[228:229], v12 offset:24640
    ds_read_b64_tr_b16 v[230:231], v12 offset:25408
    ds_read_b64_tr_b16 v[232:233], v13 offset:24672
    ds_read_b64_tr_b16 v[234:235], v13 offset:25440
    ds_read_b64_tr_b16 v[236:237], v12 offset:24704
    ds_read_b64_tr_b16 v[238:239], v12 offset:25472
    ds_read_b64_tr_b16 v[240:241], v13 offset:24736
    ds_read_b64_tr_b16 v[242:243], v13 offset:25504
    s_waitcnt vmcnt(4)
    v_max3_u32 v3, v29, v31, v33
    v_max_u32 v3, v3, v35
    v_cmp_eq_u32 vcc, -1, v3
    s_nop 1
    s_cbranch_vccnz L_f_4
L_r_5:
    s_waitcnt lgkmcnt(15)
    v_mfma_f32_16x16x32_bf16 v[100:103], a[0:3], v[28:31], 0
    buffer_load_dwordx4 v[52:55], v14, s[44:47], s71 offen offset:2048 sc1
    v_mfma_f32_16x16x32_bf16 v[104:107], a[4:7], v[28:31], 0
    ds_read_b64_tr_b16 v[244:245], v12 offset:30720
    v_mfma_f32_16x16x32_bf16 v[108:111], a[8:11], v[28:31], 0
    ds_read_b64_tr_b16 v[246:247], v12 offset:31488
    v_mfma_f32_16x16x32_bf16 v[112:115], a[12:15], v[28:31], 0
    buffer_load_dwordx4 v[56:59], v14, s[44:47], s71 offen offset:3072 sc1
    v_mfma_f32_16x16x32_bf16 v[116:119], a[16:19], v[28:31], 0
    ds_read_b64_tr_b16 v[248:249], v13 offset:30752
    v_mfma_f32_16x16x32_bf16 v[120:123], a[20:23], v[28:31], 0
    ds_read_b64_tr_b16 v[250:251], v13 offset:31520
    v_mfma_f32_16x16x32_bf16 v[100:103], a[24:27], v[32:35], v[100:103]
    buffer_load_dwordx4 v[60:63], v14, s[44:47], s72 offen offset:0 sc1
    v_mfma_f32_16x16x32_bf16 v[104:107], a[28:31], v[32:35], v[104:107]
    ds_read_b64_tr_b16 v[252:253], v12 offset:30784
    v_mfma_f32_16x16x32_bf16 v[108:111], a[32:35], v[32:35], v[108:111]
    ds_read_b64_tr_b16 v[254:255], v12 offset:31552
    v_mfma_f32_16x16x32_bf16 v[112:115], a[36:39], v[32:35], v[112:115]
    s_waitcnt vmcnt(5)
    v_max3_u32 v3, v37, v39, v41
    v_mfma_f32_16x16x32_bf16 v[116:119], a[40:43], v[32:35], v[116:119]
    v_max_u32 v3, v3, v43
    v_cmp_eq_u32 vcc, -1, v3
    v_mfma_f32_16x16x32_bf16 v[120:123], a[44:47], v[32:35], v[120:123]
    s_cbranch_vccnz L_f_6
L_r_7:
    v_mfma_f32_16x16x32_bf16 v[100:103], a[48:51], v[36:39], v[100:103]
    buffer_load_dwordx4 v[64:67], v14, s[44:47], s72 offen offset:1024 sc1
    v_mfma_f32_16x16x32_bf16 v[104:107], a[52:55], v[36:39], v[104:107]
    ds_read_b64_tr_b16 a[240:241], v13 offset:30816
    v_mfma_f32_16x16x32_bf16 v[108:111], a[56:59], v[36:39], v[108:111]
    ds_read_b64_tr_b16 a[242:243], v13 offset:31584
    v_mfma_f32_16x16x32_bf16 v[112:115], a[60:63], v[36:39], v[112:115]
    buffer_load_dwordx4 v[68:71], v14, s[44:47], s72 offen offset:2048 sc1
    v_mfma_f32_16x16x32_bf16 v[116:119], a[64:67], v[36:39], v[116:119]
    ds_read_b64_tr_b16 a[244:245], v12 offset:30848
    v_mfma_f32_16x16x32_bf16 v[120:123], a[68:71], v[36:39], v[120:123]
    ds_read_b64_tr_b16 a[246:247], v12 offset:31616
    v_mfma_f32_16x16x32_bf16 v[100:103], a[72:75], v[40:43], v[100:103]
    buffer_load_dwordx4 v[72:75], v14, s[44:47], s72 offen offset:3072 sc1
    v_mfma_f32_16x16x32_bf16 v[104:107], a[76:79], v[40:43], v[104:107]
    ds_read_b64_tr_b16 a[248:249], v13 offset:30880
    v_mfma_f32_16x16x32_bf16 v[108:111], a[80:83], v[40:43], v[108:111]
    ds_read_b64_tr_b16 a[250:251], v13 offset:31648
    v_mfma_f32_16x16x32_bf16 v[112:115], a[84:87], v[40:43], v[112:115]
    s_waitcnt vmcnt(6)
    v_max3_u32 v3, v45, v47, v49
    v_mfma_f32_16x16x32_bf16 v[116:119], a[88:91], v[40:43], v[116:119]
    v_max_u32 v3, v3, v51
    v_cmp_eq_u32 vcc, -1, v3
    v_mfma_f32_16x16x32_bf16 v[120:123], a[92:95], v[40:43], v[120:123]
    s_cbranch_vccnz L_f_8
L_r_9:
    v_mfma_f32_16x16x32_bf16 v[100:103], a[96:99], v[44:47], v[100:103]
    buffer_load_dwordx4 v[76:79], v14, s[44:47], s73 offen offset:0 sc1
    v_mfma_f32_16x16x32_bf16 v[104:107], a[100:103], v[44:47], v[104:107]
    ds_read_b64_tr_b16 a[0:1], v12 offset:36864
    v_mfma_f32_16x16x32_bf16 v[108:111], a[104:107], v[44:47], v[108:111]
    ds_read_b64_tr_b16 a[2:3], v12 offset:37632
    v_mfma_f32_16x16x32_bf16 v[112:115], a[108:111], v[44:47], v[112:115]
    buffer_load_dwordx4 v[80:83], v14, s[44:47], s73 offen offset:1024 sc1
    v_mfma_f32_16x16x32_bf16 v[116:119], a[112:115], v[44:47], v[116:119]
    ds_read_b64_tr_b16 a[4:5], v13 offset:36896
    v_mfma_f32_16x16x32_bf16 v[120:123], a[116:119], v[44:47], v[120:123]
    ds_read_b64_tr_b16 a[6:7], v13 offset:37664
    v_mfma_f32_16x16x32_bf16 v[100:103], a[120:123], v[48:51], v[100:103]
    buffer_load_dwordx4 v[84:87], v14, s[44:47], s73 offen offset:2048 sc1
    v_mfma_f32_16x16x32_bf16 v[104:107], a[124:127], v[48:51], v[104:107]
    ds_read_b64_tr_b16 a[8:9], v12 offset:36928
    v_mfma_f32_16x16x32_bf16 v[108:111], a[128:131], v[48:51], v[108:111]
    ds_read_b64_tr_b16 a[10:11], v12 offset:37696
    v_mfma_f32_16x16x32_bf16 v[112:115], a[132:135], v[48:51], v[112:115]
    s_waitcnt vmcnt(7)
    v_max3_u32 v3, v53, v55, v57
    v_mfma_f32_16x16x32_bf16 v[116:119], a[136:139], v[48:51], v[116:119]
    v_max_u32 v3, v3, v59
    v_cmp_eq_u32 vcc, -1, v3
    v_mfma_f32_16x16x32_bf16 v[120:123], a[140:143], v[48:51], v[120:123]
    s_cbranch_vccnz L_f_10
L_r_11:
    v_mfma_f32_16x16x32_bf16 v[100:103], a[144:147], v[52:55], v[100:103]
    buffer_load_dwordx4 v[88:91], v14, s[44:47], s73 offen offset:3072 sc1
    v_mfma_f32_16x16x32_bf16 v[104:107], a[148:151], v[52:55], v[104:107]
    ds_read_b64_tr_b16 a[12:13], v13 offset:36960
    v_mfma_f32_16x16x32_bf16 v[108:111], a[152:155], v[52:55], v[108:111]
    ds_read_b64_tr_b16 a[14:15], v13 offset:37728
    v_mfma_f32_16x16x32_bf16 v[112:115], a[156:159], v[52:55], v[112:115]
    buffer_load_dwordx2 v[92:93], v16, s[44:47], 0 offen offset:0 sc1
    v_mfma_f32_16x16x32_bf16 v[116:119], a[160:163], v[52:55], v[116:119]
    ds_read_b64_tr_b16 a[16:17], v12 offset:36992
    v_mfma_f32_16x16x32_bf16 v[120:123], a[164:167], v[52:55], v[120:123]
    ds_read_b64_tr_b16 a[18:19], v12 offset:37760
    v_mfma_f32_16x16x32_bf16 v[100:103], a[168:171], v[56:59], v[100:103]
    buffer_load_dwordx2 v[94:95], v16, s[44:47], 0 offen offset:384 sc1
    v_mfma_f32_16x16x32_bf16 v[104:107], a[172:175], v[56:59], v[104:107]
    ds_read_b64_tr_b16 a[20:21], v13 offset:37024
    v_mfma_f32_16x16x32_bf16 v[108:111], a[176:179], v[56:59], v[108:111]
    ds_read_b64_tr_b16 a[22:23], v13 offset:37792
    v_mfma_f32_16x16x32_bf16 v[112:115], a[180:183], v[56:59], v[112:115]
    s_waitcnt vmcnt(8)
    v_max3_u32 v3, v61, v63, v65
    v_mfma_f32_16x16x32_bf16 v[116:119], a[184:187], v[56:59], v[116:119]
    v_max_u32 v3, v3, v67
    v_cmp_eq_u32 vcc, -1, v3
    v_mfma_f32_16x16x32_bf16 v[120:123], a[188:191], v[56:59], v[120:123]
    s_cbranch_vccnz L_f_12
L_r_13:
    v_mfma_f32_16x16x32_bf16 v[100:103], a[192:195], v[60:63], v[100:103]
    buffer_load_dwordx2 v[96:97], v16, s[44:47], 0 offen offset:3072 sc1
    v_mfma_f32_16x16x32_bf16 v[104:107], a[196:199], v[60:63], v[104:107]
    ds_read_b64_tr_b16 a[24:25], v12 offset:43008
    v_mfma_f32_16x16x32_bf16 v[108:111], a[200:203], v[60:63], v[108:111]
    ds_read_b64_tr_b16 a[26:27], v12 offset:43776
    v_mfma_f32_16x16x32_bf16 v[112:115], a[204:207], v[60:63], v[112:115]
    ds_read_b64_tr_b16 a[28:29], v13 offset:43040
    v_mfma_f32_16x16x32_bf16 v[116:119], a[208:211], v[60:63], v[116:119]
    buffer_load_dwordx2 v[98:99], v16, s[44:47], 0 offen offset:3456 sc1
    v_mfma_f32_16x16x32_bf16 v[120:123], a[212:215], v[60:63], v[120:123]
    ds_read_b64_tr_b16 a[30:31], v13 offset:43808
    v_mfma_f32_16x16x32_bf16 v[100:103], a[216:219], v[64:67], v[100:103]
    ds_read_b64_tr_b16 a[32:33], v12 offset:43072
    v_mfma_f32_16x16x32_bf16 v[104:107], a[220:223], v[64:67], v[104:107]
    ds_read_b64_tr_b16 a[34:35], v12 offset:43840
    v_mfma_f32_16x16x32_bf16 v[108:111], a[224:227], v[64:67], v[108:111]
    v_mfma_f32_16x16x32_bf16 v[112:115], a[228:231], v[64:67], v[112:115]
    s_waitcnt vmcnt(8)
    v_max3_u32 v3, v69, v71, v73
    v_mfma_f32_16x16x32_bf16 v[116:119], a[232:235], v[64:67], v[116:119]
    v_max_u32 v3, v3, v75
    v_cmp_eq_u32 vcc, -1, v3
    v_mfma_f32_16x16x32_bf16 v[120:123], a[236:239], v[64:67], v[120:123]
    s_cbranch_vccnz L_f_14
L_r_15:
    v_mfma_f32_16x16x32_bf16 v[100:103], v[124:127], v[68:71], v[100:103]
    ds_read_b64_tr_b16 a[36:37], v13 offset:43104
    v_mfma_f32_16x16x32_bf16 v[104:107], v[128:131], v[68:71], v[104:107]
    ds_read_b64_tr_b16 a[38:39], v13 offset:43872
    v_mfma_f32_16x16x32_bf16 v[108:111], v[132:135], v[68:71], v[108:111]
    v_mfma_f32_16x16x32_bf16 v[112:115], v[136:139], v[68:71], v[112:115]
    ds_read_b64_tr_b16 a[40:41], v12 offset:43136
    v_mfma_f32_16x16x32_bf16 v[116:119], v[140:143], v[68:71], v[116:119]
    ds_read_b64_tr_b16 a[42:43], v12 offset:43904
    v_mfma_f32_16x16x32_bf16 v[120:123], v[144:147], v[68:71], v[120:123]
    v_mfma_f32_16x16x32_bf16 v[100:103], v[148:151], v[72:75], v[100:103]
    ds_read_b64_tr_b16 a[44:45], v13 offset:43168
    v_mfma_f32_16x16x32_bf16 v[104:107], v[152:155], v[72:75], v[104:107]
    ds_read_b64_tr_b16 a[46:47], v13 offset:43936
    v_mfma_f32_16x16x32_bf16 v[108:111], v[156:159], v[72:75], v[108:111]
    v_mfma_f32_16x16x32_bf16 v[112:115], v[160:163], v[72:75], v[112:115]
    s_waitcnt vmcnt(6)
    v_max3_u32 v3, v77, v79, v81
    v_mfma_f32_16x16x32_bf16 v[116:119], v[164:167], v[72:75], v[116:119]
    v_max_u32 v3, v3, v83
    v_cmp_eq_u32 vcc, -1, v3
    v_mfma_f32_16x16x32_bf16 v[120:123], v[168:171], v[72:75], v[120:123]
    s_cbranch_vccnz L_f_16
L_r_17:
    v_mfma_f32_16x16x32_bf16 v[100:103], v[172:175], v[76:79], v[100:103]
    v_mfma_f32_16x16x32_bf16 v[104:107], v[176:179], v[76:79], v[104:107]
    v_mfma_f32_16x16x32_bf16 v[108:111], v[180:183], v[76:79], v[108:111]
    v_mfma_f32_16x16x32_bf16 v[112:115], v[184:187], v[76:79], v[112:115]
    v_mfma_f32_16x16x32_bf16 v[116:119], v[188:191], v[76:79], v[116:119]
    v_mfma_f32_16x16x32_bf16 v[120:123], v[192:195], v[76:79], v[120:123]
    v_mfma_f32_16x16x32_bf16 v[100:103], v[196:199], v[80:83], v[100:103]
    v_mfma_f32_16x16x32_bf16 v[104:107], v[200:203], v[80:83], v[104:107]
    v_mfma_f32_16x16x32_bf16 v[108:111], v[204:207], v[80:83], v[108:111]
    v_mfma_f32_16x16x32_bf16 v[112:115], v[208:211], v[80:83], v[112:115]
    s_waitcnt vmcnt(0)
    v_max3_u32 v3, v85, v87, v89
    v_max3_u32 v3, v3, v91, v93
    s_waitcnt lgkmcnt(15)
    v_mfma_f32_16x16x32_bf16 v[116:119], v[212:215], v[80:83], v[116:119]
    v_max3_u32 v3, v3, v95, v97
    v_max_u32 v3, v3, v99
    v_cmp_eq_u32 vcc, -1, v3
    v_mfma_f32_16x16x32_bf16 v[120:123], v[216:219], v[80:83], v[120:123]
    s_cbranch_vccnz L_f_18
L_r_19:
    v_mfma_f32_16x16x32_bf16 v[100:103], v[220:223], v[84:87], v[100:103]
    v_mfma_f32_16x16x32_bf16 v[104:107], v[224:227], v[84:87], v[104:107]
    v_mfma_f32_16x16x32_bf16 v[100:103], v[244:247], v[88:91], v[100:103]
    v_mfma_f32_16x16x32_bf16 v[104:107], v[248:251], v[88:91], v[104:107]
    v_mfma_f32_16x16x32_bf16 v[100:103], a[0:3], v[92:95], v[100:103]
    v_mfma_f32_16x16x32_bf16 v[104:107], a[4:7], v[92:95], v[104:107]
    s_waitcnt lgkmcnt(10)
    v_mfma_f32_16x16x32_bf16 v[100:103], a[24:27], v[96:99], v[100:103]
    s_waitcnt lgkmcnt(8)
    v_mfma_f32_16x16x32_bf16 v[104:107], a[28:31], v[96:99], v[104:107]
    v_mfma_f32_16x16x32_bf16 v[108:111], v[228:231], v[84:87], v[108:111]
    v_mfma_f32_16x16x32_bf16 v[112:115], v[232:235], v[84:87], v[112:115]
    v_mfma_f32_16x16x32_bf16 v[108:111], v[252:255], v[88:91], v[108:111]
    v_mfma_f32_16x16x32_bf16 v[112:115], a[240:243], v[88:91], v[112:115]
    s_nop 1
    v_cvt_pk_bf16_f32 v28, v100, v101
    v_cvt_pk_bf16_f32 v29, v102, v103
    v_mfma_f32_16x16x32_bf16 v[108:111], a[8:11], v[92:95], v[108:111]
    v_cvt_pk_bf16_f32 v30, v104, v105
    v_cvt_pk_bf16_f32 v31, v106, v107
    v_mfma_f32_16x16x32_bf16 v[112:115], a[12:15], v[92:95], v[112:115]
    v_permlane16_swap_b32 v28, v30
    v_permlane16_swap_b32 v29, v31
    s_waitcnt lgkmcnt(6)
    v_mfma_f32_16x16x32_bf16 v[108:111], a[32:35], v[96:99], v[108:111]
    buffer_store_dwordx4 v[28:31], v15, s[48:51], 0 offen offset:1152
    s_waitcnt lgkmcnt(4)
    v_mfma_f32_16x16x32_bf16 v[112:115], a[36:39], v[96:99], v[112:115]
    v_mfma_f32_16x16x32_bf16 v[116:119], v[236:239], v[84:87], v[116:119]
    v_mfma_f32_16x16x32_bf16 v[120:123], v[240:243], v[84:87], v[120:123]
    v_mfma_f32_16x16x32_bf16 v[116:119], a[244:247], v[88:91], v[116:119]
    v_mfma_f32_16x16x32_bf16 v[120:123], a[248:251], v[88:91], v[120:123]
    s_nop 0
    v_cvt_pk_bf16_f32 v32, v108, v109
    v_cvt_pk_bf16_f32 v33, v110, v111
    v_mfma_f32_16x16x32_bf16 v[116:119], a[16:19], v[92:95], v[116:119]
    v_cvt_pk_bf16_f32 v34, v112, v113
    v_cvt_pk_bf16_f32 v35, v114, v115
    v_mfma_f32_16x16x32_bf16 v[120:123], a[20:23], v[92:95], v[120:123]
    v_permlane16_swap_b32 v32, v34
    v_permlane16_swap_b32 v33, v35
    s_waitcnt lgkmcnt(2)
    v_mfma_f32_16x16x32_bf16 v[116:119], a[40:43], v[96:99], v[116:119]
    buffer_store_dwordx4 v[32:35], v15, s[48:51], 0 offen offset:1216
    s_waitcnt lgkmcnt(0)
    v_mfma_f32_16x16x32_bf16 v[120:123], a[44:47], v[96:99], v[120:123]
    s_nop 4
    v_cvt_pk_bf16_f32 v36, v116, v117
    v_cvt_pk_bf16_f32 v37, v118, v119
    s_nop 0
    v_cvt_pk_bf16_f32 v38, v120, v121
    v_cvt_pk_bf16_f32 v39, v122, v123
    s_nop 0
    v_permlane16_swap_b32 v36, v38
    v_permlane16_swap_b32 v37, v39
    buffer_store_dwordx4 v[36:39], v15, s[48:51], 0 offen offset:1280
    s_endpgm
L_poll_2:
    buffer_load_dword v4, v255, s[52:55], 0 offen sc1
    s_sub_u32 s26, s26, 65536
    s_cmp_eq_u32 s26, 0
    s_cbranch_scc1 L_pok_3
    s_waitcnt vmcnt(0)
    v_or_b32 v4, s11, v4
    v_cmp_ne_u32 s[12:13], -1, v4
    s_nop 0
    s_cmp_lg_u64 s[12:13], 0
    s_cbranch_scc1 L_poll_2
    s_branch L_pok_3
L_f_4:
    buffer_load_dwordx4 v[28:31], v14, s[44:47], s70 offen offset:0 sc1
    buffer_load_dwordx4 v[32:35], v14, s[44:47], s70 offen offset:1024 sc1
    s_waitcnt vmcnt(5)
    buffer_load_dwordx4 v[36:39], v14, s[44:47], s70 offen offset:2048 sc1
    s_waitcnt vmcnt(5)
    buffer_load_dwordx4 v[40:43], v14, s[44:47], s70 offen offset:3072 sc1
    s_waitcnt vmcnt(5)
    buffer_load_dwordx4 v[44:47], v14, s[44:47], s71 offen offset:0 sc1
    s_waitcnt vmcnt(5)
    buffer_load_dwordx4 v[48:51], v14, s[44:47], s71 offen offset:1024 sc1
    s_sub_u32 s26, s26, 1
    s_waitcnt vmcnt(0)
    s_cbranch_scc1 L_r_5
    v_max3_u32 v3, v29, v31, v33
    v_max_u32 v3, v3, v35
    v_cmp_eq_u32 vcc, -1, v3
    s_nop 1
    s_cbranch_vccnz L_f_4
    s_branch L_r_5
L_f_6:
    buffer_load_dwordx4 v[36:39], v14, s[44:47], s70 offen offset:2048 sc1
    buffer_load_dwordx4 v[40:43], v14, s[44:47], s70 offen offset:3072 sc1
    s_waitcnt vmcnt(6)
    buffer_load_dwordx4 v[44:47], v14, s[44:47], s71 offen offset:0 sc1
    s_waitcnt vmcnt(6)
    buffer_load_dwordx4 v[48:51], v14, s[44:47], s71 offen offset:1024 sc1
    s_waitcnt vmcnt(6)
    buffer_load_dwordx4 v[52:55], v14, s[44:47], s71 offen offset:2048 sc1
    s_waitcnt vmcnt(6)
    buffer_load_dwordx4 v[56:59], v14, s[44:47], s71 offen offset:3072 sc1
    s_waitcnt vmcnt(6)
    buffer_load_dwordx4 v[60:63], v14, s[44:47], s72 offen offset:0 sc1
    s_sub_u32 s26, s26, 1
    s_waitcnt vmcnt(0)
    s_cbranch_scc1 L_r_7
    v_max3_u32 v3, v37, v39, v41
    v_max_u32 v3, v3, v43
    v_cmp_eq_u32 vcc, -1, v3
    s_nop 1
    s_cbranch_vccnz L_f_6
    s_branch L_r_7
L_f_8:
    buffer_load_dwordx4 v[44:47], v14, s[44:47], s71 offen offset:0 sc1
    buffer_load_dwordx4 v[48:51], v14, s[44:47], s71 offen offset:1024 sc1
    s_waitcnt vmcnt(7)
    buffer_load_dwordx4 v[52:55], v14, s[44:47], s71 offen offset:2048 sc1
    s_waitcnt vmcnt(7)
    buffer_load_dwordx4 v[56:59], v14, s[44:47], s71 offen offset:3072 sc1
    s_waitcnt vmcnt(7)
    buffer_load_dwordx4 v[60:63], v14, s[44:47], s72 offen offset:0 sc1
    s_waitcnt vmcnt(7)
    buffer_load_dwordx4 v[64:67], v14, s[44:47], s72 offen offset:1024 sc1
    s_waitcnt vmcnt(7)
    buffer_load_dwordx4 v[68:71], v14, s[44:47], s72 offen offset:2048 sc1
    s_waitcnt vmcnt(7)
    buffer_load_dwordx4 v[72:75], v14, s[44:47], s72 offen offset:3072 sc1
    s_sub_u32 s26, s26, 1
    s_waitcnt vmcnt(0)
    s_cbranch_scc1 L_r_9
    v_max3_u32 v3, v45, v47, v49
    v_max_u32 v3, v3, v51
    v_cmp_eq_u32 vcc, -1, v3
    s_nop 1
    s_cbranch_vccnz L_f_8
    s_branch L_r_9
L_f_10:
    buffer_load_dwordx4 v[52:55], v14, s[44:47], s71 offen offset:2048 sc1
    buffer_load_dwordx4 v[56:59], v14, s[44:47], s71 offen offset:3072 sc1
    s_waitcnt vmcnt(8)
    buffer_load_dwordx4 v[60:63], v14, s[44:47], s72 offen offset:0 sc1
    s_waitcnt vmcnt(8)
    buffer_load_dwordx4 v[64:67], v14, s[44:47], s72 offen offset:1024 sc1
    s_waitcnt vmcnt(8)
    buffer_load_dwordx4 v[68:71], v14, s[44:47], s72 offen offset:2048 sc1
    s_waitcnt vmcnt(8)
    buffer_load_dwordx4 v[72:75], v14, s[44:47], s72 offen offset:3072 sc1
    s_waitcnt vmcnt(8)
    buffer_load_dwordx4 v[76:79], v14, s[44:47], s73 offen offset:0 sc1
    s_waitcnt vmcnt(8)
    buffer_load_dwordx4 v[80:83], v14, s[44:47], s73 offen offset:1024 sc1
    s_sub_u32 s26, s26, 1
    s_waitcnt vmcnt(0)
    s_cbranch_scc1 L_r_11
    v_max3_u32 v3, v53, v55, v57
    v_max_u32 v3, v3, v59
    v_cmp_eq_u32 vcc, -1, v3
    s_nop 1
    s_cbranch_vccnz L_f_10
    s_branch L_r_11
L_f_12:
    buffer_load_dwordx4 v[60:63], v14, s[44:47], s72 offen offset:0 sc1
    buffer_load_dwordx4 v[64:67], v14, s[44:47], s72 offen offset:1024 sc1
    s_waitcnt vmcnt(9)
    buffer_load_dwordx4 v[68:71], v14, s[44:47], s72 offen offset:2048 sc1
    s_waitcnt vmcnt(9)
    buffer_load_dwordx4 v[72:75], v14, s[44:47], s72 offen offset:3072 sc1
    s_waitcnt vmcnt(9)
    buffer_load_dwordx4 v[76:79], v14, s[44:47], s73 offen offset:0 sc1
    s_waitcnt vmcnt(9)
    buffer_load_dwordx4 v[80:83], v14, s[44:47], s73 offen offset:1024 sc1
    s_waitcnt vmcnt(9)
    buffer_load_dwordx4 v[84:87], v14, s[44:47], s73 offen offset:2048 sc1
    s_waitcnt vmcnt(9)
    buffer_load_dwordx4 v[88:91], v14, s[44:47], s73 offen offset:3072 sc1
    s_sub_u32 s26, s26, 1
    s_waitcnt vmcnt(0)
    s_cbranch_scc1 L_r_13
    v_max3_u32 v3, v61, v63, v65
    v_max_u32 v3, v3, v67
    v_cmp_eq_u32 vcc, -1, v3
    s_nop 1
    s_cbranch_vccnz L_f_12
    s_branch L_r_13
L_f_14:
    buffer_load_dwordx4 v[68:71], v14, s[44:47], s72 offen offset:2048 sc1
    buffer_load_dwordx4 v[72:75], v14, s[44:47], s72 offen offset:3072 sc1
    s_waitcnt vmcnt(9)
    buffer_load_dwordx4 v[76:79], v14, s[44:47], s73 offen offset:0 sc1
    s_waitcnt vmcnt(9)
    buffer_load_dwordx4 v[80:83], v14, s[44:47], s73 offen offset:1024 sc1
    s_waitcnt vmcnt(9)
    buffer_load_dwordx4 v[84:87], v14, s[44:47], s73 offen offset:2048 sc1
    s_waitcnt vmcnt(9)
    buffer_load_dwordx4 v[88:91], v14, s[44:47], s73 offen offset:3072 sc1
    s_waitcnt vmcnt(9)
    buffer_load_dwordx2 v[92:93], v16, s[44:47], 0 offen offset:0 sc1
    s_waitcnt vmcnt(9)
    buffer_load_dwordx2 v[94:95], v16, s[44:47], 0 offen offset:384 sc1
    s_sub_u32 s26, s26, 1
    s_waitcnt vmcnt(0)
    s_cbranch_scc1 L_r_15
    v_max3_u32 v3, v69, v71, v73
    v_max_u32 v3, v3, v75
    v_cmp_eq_u32 vcc, -1, v3
    s_nop 1
    s_cbranch_vccnz L_f_14
    s_branch L_r_15
L_f_16:
    buffer_load_dwordx4 v[76:79], v14, s[44:47], s73 offen offset:0 sc1
    buffer_load_dwordx4 v[80:83], v14, s[44:47], s73 offen offset:1024 sc1
    s_waitcnt vmcnt(7)
    buffer_load_dwordx4 v[84:87], v14, s[44:47], s73 offen offset:2048 sc1
    s_waitcnt vmcnt(7)
    buffer_load_dwordx4 v[88:91], v14, s[44:47], s73 offen offset:3072 sc1
    s_waitcnt vmcnt(7)
    buffer_load_dwordx2 v[92:93], v16, s[44:47], 0 offen offset:0 sc1
    s_waitcnt vmcnt(7)
    buffer_load_dwordx2 v[94:95], v16, s[44:47], 0 offen offset:384 sc1
    s_waitcnt vmcnt(7)
    buffer_load_dwordx2 v[96:97], v16, s[44:47], 0 offen offset:3072 sc1
    s_waitcnt vmcnt(7)
    buffer_load_dwordx2 v[98:99], v16, s[44:47], 0 offen offset:3456 sc1
    s_sub_u32 s26, s26, 1
    s_waitcnt vmcnt(0)
    s_cbranch_scc1 L_r_17
    v_max3_u32 v3, v77, v79, v81
    v_max_u32 v3, v3, v83
    v_cmp_eq_u32 vcc, -1, v3
    s_nop 1
    s_cbranch_vccnz L_f_16
    s_branch L_r_17
L_f_18:
    buffer_load_dwordx4 v[84:87], v14, s[44:47], s73 offen offset:2048 sc1
    buffer_load_dwordx4 v[88:91], v14, s[44:47], s73 offen offset:3072 sc1
    buffer_load_dwordx2 v[92:93], v16, s[44:47], 0 offen offset:0 sc1
    buffer_load_dwordx2 v[94:95], v16, s[44:47], 0 offen offset:384 sc1
    buffer_load_dwordx2 v[96:97], v16, s[44:47], 0 offen offset:3072 sc1
    buffer_load_dwordx2 v[98:99], v16, s[44:47], 0 offen offset:3456 sc1
    s_sub_u32 s26, s26, 1
    s_waitcnt vmcnt(0)
    s_cbranch_scc1 L_r_19
    v_max3_u32 v3, v85, v87, v89
    v_max3_u32 v3, v3, v91, v93
    v_max3_u32 v3, v3, v95, v97
    v_max_u32 v3, v3, v99
    v_cmp_eq_u32 vcc, -1, v3
    s_nop 1
    s_cbranch_vccnz L_f_18
    s_branch L_r_19
L_A:
    v_lshrrev_b32 v1, 6, v0
    v_and_b32 v0, 63, v0
    v_readfirstlane_b32 s56, v1
    s_and_b32 s57, s2, 7
    s_lshr_b32 s58, s2, 3
    v_and_b32 v1, 15, v0
    v_lshrrev_b32 v2, 4, v0
    s_mov_b32 s46, 7340032
    s_mov_b32 s47, 0x20000
    s_mov_b32 s50, 4718592
    s_mov_b32 s51, 0x20000
    s_mov_b32 s54, 256
    s_mov_b32 s55, 0x20000
    s_sub_u32 s58, s58, 24
    s_lshl_b32 s59, s57, 1
    s_lshr_b32 s61, s58, 2
    s_add_u32 s59, s59, s61
    s_and_b32 s60, s58, 3
    s_mov_b32 s30, 2359296
    s_mov_b32 s31, 0x20000
    s_mov_b32 s38, 663552
    s_mov_b32 s39, 0x20000
    s_mov_b32 s42, 2359296
    s_mov_b32 s43, 0x20000
    s_mul_i32 s27, s56, 20480
    v_lshrrev_b32 v3, 3, v0
    v_and_b32 v4, 7, v0
    s_lshl_b32 s61, s59, 3
    s_lshl_b32 s62, s56, 1
    s_add_u32 s61, s61, s62
    v_add_u32 v5, 0, v3
    v_lshrrev_b32 v6, 1, v5
    v_xor_b32 v6, v6, v4
    v_lshl_add_u32 v5, v5, 7, s61
    v_add_u32 v5, 0, v5
    v_mul_u32_u24 v5, 1152, v5
    v_lshl_add_u32 v10, v6, 4, v5
    v_add_u32 v5, 8, v3
    v_lshrrev_b32 v6, 1, v5
    v_xor_b32 v6, v6, v4
    v_lshl_add_u32 v5, v5, 7, s61
    v_add_u32 v5, 0, v5
    v_mul_u32_u24 v5, 1152, v5
    v_lshl_add_u32 v11, v6, 4, v5
    v_add_u32 v5, 0, v3
    v_lshrrev_b32 v6, 1, v5
    v_xor_b32 v6, v6, v4
    v_lshl_add_u32 v5, v5, 7, s61
    v_add_u32 v5, 1, v5
    v_mul_u32_u24 v5, 1152, v5
    v_lshl_add_u32 v12, v6, 4, v5
    v_add_u32 v5, 8, v3
    v_lshrrev_b32 v6, 1, v5
    v_xor_b32 v6, v6, v4
    v_lshl_add_u32 v5, v5, 7, s61
    v_add_u32 v5, 1, v5
    v_mul_u32_u24 v5, 1152, v5
    v_lshl_add_u32 v13, v6, 4, v5
    s_mov_b32 s79, s60
    s_lshl_b32 s70, s79, 7
    s_add_u32 s74, s70, 512
    s_sub_u32 s61, s74, 1152
    s_min_u32 s74, s74, s61
    s_waitcnt lgkmcnt(0)
    s_mov_b64 s[28:29], s[4:5]
    s_mov_b64 s[36:37], s[18:19]
    s_mov_b64 s[40:41], s[14:15]
    s_mov_b64 s[44:45], s[24:25]
    s_mov_b64 s[48:49], s[20:21]
    s_mov_b64 s[52:53], s[22:23]
    s_add_u32 s75, s70, 640
    s_sub_u32 s61, s75, 1152
    s_min_u32 s75, s75, s61
    s_add_u32 s71, s70, 128
    s_sub_u32 s61, s71, 1152
    s_min_u32 s71, s71, s61
    s_add_u32 s76, s70, 768
    s_sub_u32 s61, s76, 1152
    s_min_u32 s76, s76, s61
    s_add_u32 s72, s70, 256
    s_sub_u32 s61, s72, 1152
    s_min_u32 s72, s72, s61
    s_add_u32 s77, s70, 896
    s_sub_u32 s61, s77, 1152
    s_min_u32 s77, s77, s61
    s_add_u32 s73, s70, 384
    s_sub_u32 s61, s73, 1152
    s_min_u32 s73, s73, s61
    s_add_u32 s78, s70, 1024
    s_sub_u32 s61, s78, 1152
    s_min_u32 s78, s78, s61
    s_lshl_b32 s8, s58, 2
    s_add_u32 s8, s8, s56
    s_lshr_b32 s9, s57, 1
    s_and_b32 s10, s57, 1
    s_lshl_b32 s11, s57, 2
    s_lshr_b32 s11, 0x41066330, s11
    s_and_b32 s11, s11, 15
    s_mul_i32 s9, s9, 528
    s_mul_i32 s10, s8, 17
    s_add_u32 s9, s9, s10
    s_sub_u32 s9, s9, 8
    v_and_b32 v16, 31, v0
    v_lshrrev_b32 v19, 5, v0
    v_mov_b32 v27, 2147483648
    v_cmp_gt_u32 vcc, 17, v16
    v_add_u32 v16, s9, v16
    s_nop 0
    v_cndmask_b32 v16, v27, v16, vcc
    v_and_b32 v17, 1023, v16
    v_lshrrev_b32 v15, 10, v16
    v_lshl_or_b32 v17, v17, 1, v15
    v_mul_u32_u24 v17, 1152, v17
    v_cmp_gt_u32 vcc, 2048, v16
    s_nop 1
    v_cndmask_b32 v15, v27, v17, vcc
    s_add_u32 s9, s11, 3
    s_sub_u32 s12, s9, 9
    s_min_u32 s9, s9, s12
    s_add_u32 s10, s11, 4
    s_sub_u32 s12, s10, 9
    s_min_u32 s10, s10, s12
    s_sub_u32 s10, s10, s9
    s_mul_i32 s12, s10, 128
    s_mul_i32 s13, s9, 128
    v_mad_i32_i24 v16, v19, s12, v15
    v_add_u32 v16, s13, v16
    buffer_load_dword v18, v16, s[40:43], 0 offen
    v_lshrrev_b32 v4, 1, v1
    v_xor_b32 v4, v4, v2
    v_lshlrev_b32 v4, 4, v4
    v_lshl_add_u32 v4, v1, 7, v4
    v_add_u32 v20, s27, v4
    v_xor_b32 v21, 64, v20
    v_lshlrev_b32 v4, 4, v0
    v_add_u32 v22, 81920, v4
    v_add_u32 v23, 122880, v4
    s_lshl_b32 s61, s56, 10
    v_add_u32 v24, s61, v22
    s_lshl_b32 s61, s60, 6
    s_lshl_b32 s62, s59, 2
    s_add_u32 s61, s61, s62
    s_add_u32 s61, s61, s56
    s_lshl_b32 s62, s61, 7
    s_lshl_b32 s61, s61, 4
    s_add_u32 s61, s61, 2392064
    v_mov_b32 v4, s61
    v_mov_b32 v9, 2147483648
    v_cmp_eq_u32 vcc, 8, v0
    s_nop 1
    v_cndmask_b32 v220, v9, v4, vcc
    s_add_u32 s62, s62, 0x240000
    v_lshl_add_u32 v4, v0, 4, s62
    v_cmp_gt_u32 vcc, 8, v0
    s_nop 1
    v_cndmask_b32 v231, v220, v4, vcc
    v_bfe_u32 v3, v0, 3, 1
    v_and_b32 v4, 7, v0
    v_lshlrev_b32 v4, 2, v4
    v_lshl_add_u32 v230, v3, 7, v4
    s_lshr_b32 s62, s60, 1
    s_mul_i32 s62, s62, 96
    s_lshl_b32 s61, s60, 4
    s_add_u32 s62, s62, s61
    s_add_u32 s62, s62, s59
    v_mov_b32 v9, 2147483648
    v_mov_b32 v4, s62
    v_or_b32 v5, s56, v0
    v_cmp_eq_u32 vcc, 0, v5
    s_nop 1
    v_cndmask_b32 v222, v9, v4, vcc
    s_sub_u32 s61, s2, 192
    s_lshl_b32 s61, s61, 2
    s_add_u32 s61, s61, s56
    s_mul_i32 s61, s61, 9216
    v_lshl_add_u32 v223, v0, 4, s61
    v_mov_b32 v232, -1
    v_mov_b32 v233, -1
    v_mov_b32 v234, -1
    v_mov_b32 v235, -1
    s_lshr_b32 s62, s60, 1
    s_mul_i32 s62, s62, 142
    s_add_u32 s62, s62, s60
    v_lshrrev_b32 v3, 1, v1
    v_and_b32 v4, 1, v1
    v_lshl_add_u32 v4, v4, 1, s62
    v_mad_u32_u24 v3, v3, 18, v4
    s_and_b32 s61, s59, 1
    s_xor_b32 s62, s56, s61
    s_lshl_b32 s62, s62, 2
    s_lshl_b32 s61, s61, 2
    s_xor_b32 s63, s61, 0
    v_add_u32 v4, s63, v3
    v_cvt_f32_u32 v4, v4
    v_mul_f32 v108, 0x3ae38e39, v4
    v_cos_f32 v114, v108
    s_xor_b32 s63, s61, 4
    v_add_u32 v4, s63, v3
    v_cvt_f32_u32 v4, v4
    v_mul_f32 v109, 0x3ae38e39, v4
    v_cos_f32 v115, v109
    s_xor_b32 s63, s61, 8
    v_add_u32 v4, s63, v3
    v_cvt_f32_u32 v4, v4
    v_mul_f32 v110, 0x3ae38e39, v4
    v_cos_f32 v116, v110
    s_xor_b32 s63, s61, 12
    v_add_u32 v4, s63, v3
    v_cvt_f32_u32 v4, v4
    v_mul_f32 v111, 0x3ae38e39, v4
    v_cos_f32 v117, v111
    v_add_u32 v4, 16, v3
    v_cvt_f32_u32 v4, v4
    v_mul_f32 v112, 0x3ae38e39, v4
    v_cos_f32 v118, v112
    v_add_u32 v4, s62, v3
    v_cvt_f32_u32 v4, v4
    v_mul_f32 v113, 0x3ae38e39, v4
    v_cos_f32 v119, v113
    v_add_f32 v114, v114, v114
    v_add_f32 v115, v115, v115
    v_add_f32 v116, v116, v116
    v_add_f32 v117, v117, v117
    v_add_f32 v118, v118, v118
    v_add_f32 v119, v119, v119
    s_lshl_b32 s61, s79, 6
    v_lshl_add_u32 v3, v2, 3, s61
    v_add_u32 v4, 256, v3
    v_cvt_f32_u32 v7, v4
    s_lshl_b32 s61, s56, 5
    v_add_u32 v3, s61, v3
    v_cvt_f32_u32 v5, v3
    v_add_f32 v6, 0x43000000, v5
    s_mul_i32 s61, s56, 10240
    v_add_u32 v8, s61, v22
    v_mul_f32 v35, v108, v5
    v_fract_f32 v35, v35
    v_add_f32 v43, v35, v108
    v_cos_f32 v28, v35
    v_sin_f32 v36, -v35
    v_cos_f32 v29, v43
    v_sin_f32 v37, -v43
    v_fma_f32 v30, v114, v29, -v28
    v_fma_f32 v38, v114, v37, -v36
    v_fma_f32 v31, v114, v30, -v29
    v_fma_f32 v39, v114, v38, -v37
    v_fma_f32 v32, v114, v31, -v30
    v_fma_f32 v40, v114, v39, -v38
    v_fma_f32 v33, v114, v32, -v31
    v_fma_f32 v41, v114, v40, -v39
    v_fma_f32 v34, v114, v33, -v32
    v_fma_f32 v42, v114, v41, -v40
    v_fma_f32 v35, v114, v34, -v33
    v_fma_f32 v43, v114, v42, -v41
    s_add_u32 m0, s27, 0
    s_nop 0
    buffer_load_dwordx4 v10, s[28:31], s74 offen lds
    v_cvt_pk_bf16_f32 v44, v28, v29
    v_cvt_pk_bf16_f32 v45, v30, v31
    v_cvt_pk_bf16_f32 v46, v32, v33
    v_cvt_pk_bf16_f32 v47, v34, v35
    v_cvt_pk_bf16_f32 v48, v36, v37
    v_cvt_pk_bf16_f32 v49, v38, v39
    v_cvt_pk_bf16_f32 v50, v40, v41
    v_cvt_pk_bf16_f32 v51, v42, v43
    ds_write_b128 v8, v[44:47] offset:0
    ds_write_b128 v8, v[48:51] offset:5120
    v_mul_f32 v59, v109, v5
    v_fract_f32 v59, v59
    v_add_f32 v67, v59, v109
    v_cos_f32 v52, v59
    v_sin_f32 v60, -v59
    v_cos_f32 v53, v67
    v_sin_f32 v61, -v67
    v_fma_f32 v54, v115, v53, -v52
    v_fma_f32 v62, v115, v61, -v60
    s_add_u32 m0, s27, 1024
    s_nop 0
    buffer_load_dwordx4 v11, s[28:31], s74 offen lds
    v_fma_f32 v55, v115, v54, -v53
    v_fma_f32 v63, v115, v62, -v61
    v_fma_f32 v56, v115, v55, -v54
    v_fma_f32 v64, v115, v63, -v62
    v_fma_f32 v57, v115, v56, -v55
    v_fma_f32 v65, v115, v64, -v63
    v_fma_f32 v58, v115, v57, -v56
    v_fma_f32 v66, v115, v65, -v64
    v_fma_f32 v59, v115, v58, -v57
    v_fma_f32 v67, v115, v66, -v65
    v_cvt_pk_bf16_f32 v68, v52, v53
    v_cvt_pk_bf16_f32 v69, v54, v55
    v_cvt_pk_bf16_f32 v70, v56, v57
    v_cvt_pk_bf16_f32 v71, v58, v59
    v_cvt_pk_bf16_f32 v72, v60, v61
    v_cvt_pk_bf16_f32 v73, v62, v63
    v_cvt_pk_bf16_f32 v74, v64, v65
    s_add_u32 m0, s27, 2048
    s_nop 0
    buffer_load_dwordx4 v12, s[28:31], s74 offen lds
    v_cvt_pk_bf16_f32 v75, v66, v67
    ds_write_b128 v8, v[68:71] offset:1024
    ds_write_b128 v8, v[72:75] offset:6144
    v_mul_f32 v83, v110, v5
    v_fract_f32 v83, v83
    v_add_f32 v91, v83, v110
    v_cos_f32 v76, v83
    v_sin_f32 v84, -v83
    v_cos_f32 v77, v91
    v_sin_f32 v85, -v91
    v_fma_f32 v78, v116, v77, -v76
    v_fma_f32 v86, v116, v85, -v84
    v_fma_f32 v79, v116, v78, -v77
    v_fma_f32 v87, v116, v86, -v85
    v_fma_f32 v80, v116, v79, -v78
    v_fma_f32 v88, v116, v87, -v86
    v_fma_f32 v81, v116, v80, -v79
    v_fma_f32 v89, v116, v88, -v87
    v_fma_f32 v82, v116, v81, -v80
    s_add_u32 m0, s27, 3072
    s_nop 0
    buffer_load_dwordx4 v13, s[28:31], s74 offen lds
    v_fma_f32 v90, v116, v89, -v88
    v_fma_f32 v83, v116, v82, -v81
    v_fma_f32 v91, v116, v90, -v89
    v_cvt_pk_bf16_f32 v92, v76, v77
    v_cvt_pk_bf16_f32 v93, v78, v79
    v_cvt_pk_bf16_f32 v94, v80, v81
    v_cvt_pk_bf16_f32 v95, v82, v83
    v_cvt_pk_bf16_f32 v96, v84, v85
    v_cvt_pk_bf16_f32 v97, v86, v87
    v_cvt_pk_bf16_f32 v98, v88, v89
    v_cvt_pk_bf16_f32 v99, v90, v91
    ds_write_b128 v8, v[92:95] offset:2048
    ds_write_b128 v8, v[96:99] offset:7168
    v_mul_f32 v35, v111, v5
    v_fract_f32 v35, v35
    v_add_f32 v43, v35, v111
    v_cos_f32 v28, v35
    v_sin_f32 v36, -v35
    v_cos_f32 v29, v43
    s_add_u32 m0, s27, 4096
    s_nop 0
    buffer_load_dwordx4 v10, s[28:31], s70 offen lds
    v_sin_f32 v37, -v43
    v_fma_f32 v30, v117, v29, -v28
    v_fma_f32 v38, v117, v37, -v36
    v_fma_f32 v31, v117, v30, -v29
    v_fma_f32 v39, v117, v38, -v37
    v_fma_f32 v32, v117, v31, -v30
    v_fma_f32 v40, v117, v39, -v38
    v_fma_f32 v33, v117, v32, -v31
    v_fma_f32 v41, v117, v40, -v39
    v_fma_f32 v34, v117, v33, -v32
    v_fma_f32 v42, v117, v41, -v40
    v_fma_f32 v35, v117, v34, -v33
    v_fma_f32 v43, v117, v42, -v41
    v_cvt_pk_bf16_f32 v44, v28, v29
    v_cvt_pk_bf16_f32 v45, v30, v31
    v_cvt_pk_bf16_f32 v46, v32, v33
    v_cvt_pk_bf16_f32 v47, v34, v35
    s_add_u32 m0, s27, 5120
    s_nop 0
    buffer_load_dwordx4 v11, s[28:31], s70 offen lds
    v_cvt_pk_bf16_f32 v48, v36, v37
    v_cvt_pk_bf16_f32 v49, v38, v39
    v_cvt_pk_bf16_f32 v50, v40, v41
    v_cvt_pk_bf16_f32 v51, v42, v43
    ds_write_b128 v8, v[44:47] offset:3072
    ds_write_b128 v8, v[48:51] offset:8192
    v_mul_f32 v59, v112, v5
    v_fract_f32 v59, v59
    v_add_f32 v67, v59, v112
    v_cos_f32 v52, v59
    v_sin_f32 v60, -v59
    v_cos_f32 v53, v67
    v_sin_f32 v61, -v67
    v_fma_f32 v54, v118, v53, -v52
    v_fma_f32 v62, v118, v61, -v60
    v_fma_f32 v55, v118, v54, -v53
    v_fma_f32 v63, v118, v62, -v61
    v_fma_f32 v56, v118, v55, -v54
    v_fma_f32 v64, v118, v63, -v62
    s_add_u32 m0, s27, 6144
    s_nop 0
    buffer_load_dwordx4 v12, s[28:31], s70 offen lds
    v_fma_f32 v57, v118, v56, -v55
    v_fma_f32 v65, v118, v64, -v63
    v_fma_f32 v58, v118, v57, -v56
    v_fma_f32 v66, v118, v65, -v64
    v_fma_f32 v59, v118, v58, -v57
    v_fma_f32 v67, v118, v66, -v65
    v_cvt_pk_bf16_f32 v68, v52, v53
    v_cvt_pk_bf16_f32 v69, v54, v55
    v_cvt_pk_bf16_f32 v70, v56, v57
    v_cvt_pk_bf16_f32 v71, v58, v59
    v_cvt_pk_bf16_f32 v72, v60, v61
    v_cvt_pk_bf16_f32 v73, v62, v63
    v_cvt_pk_bf16_f32 v74, v64, v65
    v_cvt_pk_bf16_f32 v75, v66, v67
    ds_write_b128 v8, v[68:71] offset:4096
    ds_write_b128 v8, v[72:75] offset:9216
    v_mul_f32 v83, v108, v6
    v_fract_f32 v83, v83
    v_add_f32 v91, v83, v108
    s_add_u32 m0, s27, 7168
    s_nop 0
    buffer_load_dwordx4 v13, s[28:31], s70 offen lds
    v_cos_f32 v76, v83
    v_sin_f32 v84, -v83
    v_cos_f32 v77, v91
    v_sin_f32 v85, -v91
    v_fma_f32 v78, v114, v77, -v76
    v_fma_f32 v86, v114, v85, -v84
    v_fma_f32 v79, v114, v78, -v77
    v_fma_f32 v87, v114, v86, -v85
    v_fma_f32 v80, v114, v79, -v78
    v_fma_f32 v88, v114, v87, -v86
    v_fma_f32 v81, v114, v80, -v79
    v_fma_f32 v89, v114, v88, -v87
    v_fma_f32 v82, v114, v81, -v80
    v_fma_f32 v90, v114, v89, -v88
    v_fma_f32 v83, v114, v82, -v81
    v_fma_f32 v91, v114, v90, -v89
    v_cvt_pk_bf16_f32 v92, v76, v77
    s_add_u32 m0, s27, 8192
    s_nop 0
    buffer_load_dwordx4 v10, s[28:31], s75 offen lds
    v_cvt_pk_bf16_f32 v93, v78, v79
    v_cvt_pk_bf16_f32 v94, v80, v81
    v_cvt_pk_bf16_f32 v95, v82, v83
    v_cvt_pk_bf16_f32 v96, v84, v85
    v_cvt_pk_bf16_f32 v97, v86, v87
    v_cvt_pk_bf16_f32 v98, v88, v89
    v_cvt_pk_bf16_f32 v99, v90, v91
    ds_write_b128 v8, v[92:95] offset:40960
    ds_write_b128 v8, v[96:99] offset:46080
    v_mul_f32 v35, v109, v6
    v_fract_f32 v35, v35
    v_add_f32 v43, v35, v109
    v_cos_f32 v28, v35
    v_sin_f32 v36, -v35
    v_cos_f32 v29, v43
    v_sin_f32 v37, -v43
    v_fma_f32 v30, v115, v29, -v28
    v_fma_f32 v38, v115, v37, -v36
    v_fma_f32 v31, v115, v30, -v29
    s_add_u32 m0, s27, 9216
    s_nop 0
    buffer_load_dwordx4 v11, s[28:31], s75 offen lds
    v_fma_f32 v39, v115, v38, -v37
    v_fma_f32 v32, v115, v31, -v30
    v_fma_f32 v40, v115, v39, -v38
    v_fma_f32 v33, v115, v32, -v31
    v_fma_f32 v41, v115, v40, -v39
    v_fma_f32 v34, v115, v33, -v32
    v_fma_f32 v42, v115, v41, -v40
    v_fma_f32 v35, v115, v34, -v33
    v_fma_f32 v43, v115, v42, -v41
    v_cvt_pk_bf16_f32 v44, v28, v29
    v_cvt_pk_bf16_f32 v45, v30, v31
    v_cvt_pk_bf16_f32 v46, v32, v33
    v_cvt_pk_bf16_f32 v47, v34, v35
    v_cvt_pk_bf16_f32 v48, v36, v37
    v_cvt_pk_bf16_f32 v49, v38, v39
    v_cvt_pk_bf16_f32 v50, v40, v41
    v_cvt_pk_bf16_f32 v51, v42, v43
    ds_write_b128 v8, v[44:47] offset:41984
    ds_write_b128 v8, v[48:51] offset:47104
    v_mul_f32 v59, v110, v6
    s_add_u32 m0, s27, 10240
    s_nop 0
    buffer_load_dwordx4 v12, s[28:31], s75 offen lds
    v_fract_f32 v59, v59
    v_add_f32 v67, v59, v110
    v_cos_f32 v52, v59
    v_sin_f32 v60, -v59
    v_cos_f32 v53, v67
    v_sin_f32 v61, -v67
    v_fma_f32 v54, v116, v53, -v52
    v_fma_f32 v62, v116, v61, -v60
    v_fma_f32 v55, v116, v54, -v53
    v_fma_f32 v63, v116, v62, -v61
    v_fma_f32 v56, v116, v55, -v54
    v_fma_f32 v64, v116, v63, -v62
    v_fma_f32 v57, v116, v56, -v55
    v_fma_f32 v65, v116, v64, -v63
    v_fma_f32 v58, v116, v57, -v56
    v_fma_f32 v66, v116, v65, -v64
    v_fma_f32 v59, v116, v58, -v57
    s_add_u32 m0, s27, 11264
    s_nop 0
    buffer_load_dwordx4 v13, s[28:31], s75 offen lds
    v_fma_f32 v67, v116, v66, -v65
    v_cvt_pk_bf16_f32 v68, v52, v53
    v_cvt_pk_bf16_f32 v69, v54, v55
    v_cvt_pk_bf16_f32 v70, v56, v57
    v_cvt_pk_bf16_f32 v71, v58, v59
    v_cvt_pk_bf16_f32 v72, v60, v61
    v_cvt_pk_bf16_f32 v73, v62, v63
    v_cvt_pk_bf16_f32 v74, v64, v65
    v_cvt_pk_bf16_f32 v75, v66, v67
    ds_write_b128 v8, v[68:71] offset:43008
    ds_write_b128 v8, v[72:75] offset:48128
    v_mul_f32 v83, v111, v6
    v_fract_f32 v83, v83
    v_add_f32 v91, v83, v111
    v_cos_f32 v76, v83
    v_sin_f32 v84, -v83
    v_cos_f32 v77, v91
    v_sin_f32 v85, -v91
    v_fma_f32 v78, v117, v77, -v76
    s_add_u32 m0, s27, 12288
    s_nop 0
    buffer_load_dwordx4 v10, s[28:31], s71 offen lds
    v_fma_f32 v86, v117, v85, -v84
    v_fma_f32 v79, v117, v78, -v77
    v_fma_f32 v87, v117, v86, -v85
    v_fma_f32 v80, v117, v79, -v78
    v_fma_f32 v88, v117, v87, -v86
    v_fma_f32 v81, v117, v80, -v79
    v_fma_f32 v89, v117, v88, -v87
    v_fma_f32 v82, v117, v81, -v80
    v_fma_f32 v90, v117, v89, -v88
    v_fma_f32 v83, v117, v82, -v81
    v_fma_f32 v91, v117, v90, -v89
    v_cvt_pk_bf16_f32 v92, v76, v77
    v_cvt_pk_bf16_f32 v93, v78, v79
    v_cvt_pk_bf16_f32 v94, v80, v81
    v_cvt_pk_bf16_f32 v95, v82, v83
    v_cvt_pk_bf16_f32 v96, v84, v85
    v_cvt_pk_bf16_f32 v97, v86, v87
    s_add_u32 m0, s27, 13312
    s_nop 0
    buffer_load_dwordx4 v11, s[28:31], s71 offen lds
    v_cvt_pk_bf16_f32 v98, v88, v89
    v_cvt_pk_bf16_f32 v99, v90, v91
    ds_write_b128 v8, v[92:95] offset:44032
    ds_write_b128 v8, v[96:99] offset:49152
    v_mul_f32 v35, v112, v6
    v_fract_f32 v35, v35
    v_add_f32 v43, v35, v112
    v_cos_f32 v28, v35
    v_sin_f32 v36, -v35
    v_cos_f32 v29, v43
    v_sin_f32 v37, -v43
    v_fma_f32 v30, v118, v29, -v28
    v_fma_f32 v38, v118, v37, -v36
    v_fma_f32 v31, v118, v30, -v29
    v_fma_f32 v39, v118, v38, -v37
    v_fma_f32 v32, v118, v31, -v30
    v_fma_f32 v40, v118, v39, -v38
    v_fma_f32 v33, v118, v32, -v31
    v_fma_f32 v41, v118, v40, -v39
    s_add_u32 m0, s27, 14336
    s_nop 0
    buffer_load_dwordx4 v12, s[28:31], s71 offen lds
    buffer_store_dwordx4 v[232:235], v223, s[44:47], 0 offen offset:0 sc1
    v_fma_f32 v34, v118, v33, -v32
    v_fma_f32 v42, v118, v41, -v40
    v_fma_f32 v35, v118, v34, -v33
    v_fma_f32 v43, v118, v42, -v41
    v_cvt_pk_bf16_f32 v44, v28, v29
    v_cvt_pk_bf16_f32 v45, v30, v31
    v_cvt_pk_bf16_f32 v46, v32, v33
    v_cvt_pk_bf16_f32 v47, v34, v35
    v_cvt_pk_bf16_f32 v48, v36, v37
    v_cvt_pk_bf16_f32 v49, v38, v39
    v_cvt_pk_bf16_f32 v50, v40, v41
    v_cvt_pk_bf16_f32 v51, v42, v43
    ds_write_b128 v8, v[44:47] offset:45056
    ds_write_b128 v8, v[48:51] offset:50176
    v_mul_f32 v59, v113, v7
    v_fract_f32 v59, v59
    v_add_f32 v67, v59, v113
    v_cos_f32 v52, v59
    v_sin_f32 v60, -v59
    s_add_u32 m0, s27, 15360
    s_nop 0
    buffer_load_dwordx4 v13, s[28:31], s71 offen lds
    v_cos_f32 v53, v67
    v_sin_f32 v61, -v67
    v_fma_f32 v54, v119, v53, -v52
    v_fma_f32 v62, v119, v61, -v60
    v_fma_f32 v55, v119, v54, -v53
    v_fma_f32 v63, v119, v62, -v61
    v_fma_f32 v56, v119, v55, -v54
    v_fma_f32 v64, v119, v63, -v62
    v_fma_f32 v57, v119, v56, -v55
    v_fma_f32 v65, v119, v64, -v63
    v_fma_f32 v58, v119, v57, -v56
    v_fma_f32 v66, v119, v65, -v64
    v_fma_f32 v59, v119, v58, -v57
    v_fma_f32 v67, v119, v66, -v65
    v_cvt_pk_bf16_f32 v240, v52, v53
    v_cvt_pk_bf16_f32 v241, v54, v55
    v_cvt_pk_bf16_f32 v242, v56, v57
    s_add_u32 m0, s27, 16384
    s_nop 0
    buffer_load_dwordx4 v10, s[28:31], s76 offen lds
    buffer_store_dwordx4 v[232:235], v223, s[44:47], 0 offen offset:1024 sc1
    v_cvt_pk_bf16_f32 v243, v58, v59
    v_cvt_pk_bf16_f32 v244, v60, v61
    v_cvt_pk_bf16_f32 v245, v62, v63
    v_cvt_pk_bf16_f32 v246, v64, v65
    v_cvt_pk_bf16_f32 v247, v66, v67
    v_mul_f32 v83, v112, v7
    v_fract_f32 v83, v83
    v_add_f32 v91, v83, v112
    v_cos_f32 v76, v83
    v_sin_f32 v84, -v83
    v_cos_f32 v77, v91
    v_sin_f32 v85, -v91
    v_fma_f32 v78, v118, v77, -v76
    v_fma_f32 v86, v118, v85, -v84
    v_fma_f32 v79, v118, v78, -v77
    v_fma_f32 v87, v118, v86, -v85
    v_fma_f32 v80, v118, v79, -v78
    s_add_u32 m0, s27, 17408
    s_nop 0
    buffer_load_dwordx4 v11, s[28:31], s76 offen lds
    v_fma_f32 v88, v118, v87, -v86
    v_fma_f32 v81, v118, v80, -v79
    v_fma_f32 v89, v118, v88, -v87
    v_fma_f32 v82, v118, v81, -v80
    v_fma_f32 v90, v118, v89, -v88
    v_fma_f32 v83, v118, v82, -v81
    v_fma_f32 v91, v118, v90, -v89
    v_cvt_pk_bf16_f32 v248, v76, v77
    v_cvt_pk_bf16_f32 v249, v78, v79
    v_cvt_pk_bf16_f32 v250, v80, v81
    v_cvt_pk_bf16_f32 v251, v82, v83
    v_cvt_pk_bf16_f32 v252, v84, v85
    v_cvt_pk_bf16_f32 v253, v86, v87
    v_cvt_pk_bf16_f32 v254, v88, v89
    v_cvt_pk_bf16_f32 v255, v90, v91
    v_and_b32 v3, 1, v1
    v_lshlrev_b32 v3, 4, v3
    s_add_u32 m0, s27, 18432
    s_nop 0
    buffer_load_dwordx4 v12, s[28:31], s76 offen lds
    buffer_store_dwordx4 v[232:235], v223, s[44:47], 0 offen offset:2048 sc1
    v_mov_b32 v4, 0x3f80
    v_lshlrev_b32 v3, v3, v4
    v_lshrrev_b32 v4, 1, v1
    v_lshlrev_b32 v5, 1, v2
    v_cmp_eq_u32 vcc, v4, v5
    s_nop 1
    v_cndmask_b32 v236, 0, v3, vcc
    v_add_u32 v5, 1, v5
    v_cmp_eq_u32 vcc, v4, v5
    s_nop 1
    v_cndmask_b32 v237, 0, v3, vcc
    s_and_b32 s61, s60, 1
    s_mul_i32 s61, s61, 0x80008000
    v_xor_b32 v238, s61, v236
    v_xor_b32 v239, s61, v237
    v_lshl_add_u32 v3, v2, 2, 0
    v_mul_u32_u24 v3, v3, v1
    v_and_b32 v3, 15, v3
    v_cvt_f32_u32 v3, v3
    v_mul_f32 v3, 0x3d800000, v3
    v_cos_f32 v4, v3
    s_add_u32 m0, s27, 19456
    s_nop 0
    buffer_load_dwordx4 v13, s[28:31], s76 offen lds
    v_sin_f32 v6, v3
    v_lshl_add_u32 v3, v2, 2, 1
    v_mul_u32_u24 v3, v3, v1
    v_and_b32 v3, 15, v3
    v_cvt_f32_u32 v3, v3
    v_mul_f32 v3, 0x3d800000, v3
    v_cos_f32 v5, v3
    v_sin_f32 v7, v3
    v_cvt_pk_bf16_f32 v204, v4, v5
    v_cvt_pk_bf16_f32 v206, v6, v7
    v_xor_b32 v208, 0x80008000, v204
    v_lshl_add_u32 v3, v2, 2, 2
    v_mul_u32_u24 v3, v3, v1
    v_and_b32 v3, 15, v3
    v_cvt_f32_u32 v3, v3
    v_mul_f32 v3, 0x3d800000, v3
    v_cos_f32 v4, v3
    s_add_u32 s9, s11, 5
    s_sub_u32 s12, s9, 9
    s_min_u32 s9, s9, s12
    s_add_u32 s10, s11, 6
    s_sub_u32 s12, s10, 9
    s_min_u32 s10, s10, s12
    s_sub_u32 s10, s10, s9
    s_mul_i32 s12, s10, 128
    s_mul_i32 s13, s9, 128
    v_mad_i32_i24 v16, v19, s12, v15
    v_add_u32 v16, s13, v16
    buffer_load_dword v18, v16, s[40:43], 0 offen
    v_sin_f32 v6, v3
    v_lshl_add_u32 v3, v2, 2, 3
    v_mul_u32_u24 v3, v3, v1
    v_and_b32 v3, 15, v3
    v_cvt_f32_u32 v3, v3
    v_mul_f32 v3, 0x3d800000, v3
    v_cos_f32 v5, v3
    v_sin_f32 v7, v3
    v_cvt_pk_bf16_f32 v205, v4, v5
    v_cvt_pk_bf16_f32 v207, v6, v7
    v_xor_b32 v209, 0x80008000, v205
    s_lshr_b32 s61, s59, 2
    s_lshl_b32 s61, s61, 4
    s_lshl_b32 s62, s56, 2
    s_add_u32 s61, s61, s62
    s_and_b32 s62, s59, 3
    s_add_u32 s61, s61, s62
    s_mul_i32 s61, s61, 640
    s_lshr_b32 s62, s60, 1
    s_mul_i32 s62, s62, 81792
    s_add_u32 s61, s61, s62
    s_lshl_b32 s62, s60, 6
    s_add_u32 s61, s61, s62
    s_add_u32 s61, s61, 2621440
    v_mul_u32_u24 v3, 655360, v2
    v_lshl_add_u32 v3, v1, 3, v3
    v_lshrrev_b32 v4, 3, v1
    v_mul_u32_u24 v4, 40896, v4
    v_add3_u32 v210, s61, v3, v4
    v_and_b32 v3, 7, v0
    v_lshlrev_b32 v3, 3, v3
    s_and_b32 s61, s60, 1
    s_lshl_b32 s61, s61, 6
    v_add3_u32 v26, v3, s61, v210
    s_mov_b32 s97, 163840
    s_mov_b32 s98, 327680
    s_mov_b32 s99, 491520
    s_sub_u32 s62, s2, 192
    s_lshl_b32 s62, s62, 2
    s_add_u32 s62, s62, s56
    s_mul_i32 s62, s62, 2688
    v_lshl_add_u32 v3, v0, 7, s62
    v_mov_b32 v9, 2147483648
    v_cmp_gt_u32 vcc, 21, v0
    s_nop 1
    v_cndmask_b32 v229, v9, v3, vcc
    s_waitcnt lgkmcnt(0)
    s_barrier
    ds_read_b128 a[0:3], v22 offset:0
    ds_read_b128 a[4:7], v22 offset:1024
    ds_read_b128 a[8:11], v22 offset:2048
    ds_read_b128 a[12:15], v22 offset:3072
    ds_read_b128 a[16:19], v22 offset:4096
    ds_read_b128 a[20:23], v22 offset:5120
    ds_read_b128 a[24:27], v22 offset:6144
    ds_read_b128 a[28:31], v22 offset:7168
    ds_read_b128 a[32:35], v22 offset:8192
    ds_read_b128 a[36:39], v22 offset:9216
    s_waitcnt vmcnt(16)
    ds_read_b128 v[28:31], v20 offset:4096
    ds_read_b128 v[32:35], v21 offset:0
    ds_read_b128 v[36:39], v20 offset:6144
    ds_read_b128 v[40:43], v21 offset:2048
    ds_read_b128 v[44:47], v20 offset:0
    ds_read_b128 v[52:55], v20 offset:2048
    s_waitcnt lgkmcnt(4)
    v_swap_b32 v30, v32
    v_swap_b32 v31, v33
    s_waitcnt lgkmcnt(2)
    v_swap_b32 v38, v40
    v_swap_b32 v39, v41
    v_mfma_f32_16x16x32_bf16 v[60:63], v[236:239], v[28:31], 0
    v_mfma_f32_16x16x32_bf16 v[64:67], v[236:239], v[32:35], 0
    v_mfma_f32_16x16x32_bf16 v[68:71], v[236:239], v[36:39], 0
    v_mfma_f32_16x16x32_bf16 v[72:75], v[236:239], v[40:43], 0
    s_waitcnt lgkmcnt(0)
    s_nop 3
    v_cvt_pk_bf16_f32 v76, v60, v61
    v_cvt_pk_bf16_f32 v77, v62, v63
    v_cvt_pk_bf16_f32 v78, v64, v65
    v_cvt_pk_bf16_f32 v79, v66, v67
    v_cvt_pk_bf16_f32 v80, v68, v69
    v_cvt_pk_bf16_f32 v81, v70, v71
    v_cvt_pk_bf16_f32 v82, v72, v73
    v_cvt_pk_bf16_f32 v83, v74, v75
    v_mfma_f32_16x16x32_bf16 v[124:127], v[76:79], a[0:3], 0
    s_add_u32 m0, s27, 0
    s_nop 0
    buffer_load_dwordx4 v10, s[28:31], s72 offen lds
    buffer_store_dwordx4 v[232:235], v223, s[44:47], 0 offen offset:3072 sc1
    v_mfma_f32_16x16x32_bf16 v[164:167], v[80:83], a[0:3], 0
    v_mfma_f32_16x16x32_bf16 v[132:135], v[76:79], a[4:7], 0
    s_add_u32 m0, s27, 1024
    s_nop 0
    buffer_load_dwordx4 v11, s[28:31], s72 offen lds
    v_mfma_f32_16x16x32_bf16 v[172:175], v[80:83], a[4:7], 0
    s_waitcnt vmcnt(15)
    ds_read_b128 v[28:31], v21 offset:4096
    ds_read_b128 v[32:35], v20 offset:8192
    v_mfma_f32_16x16x32_bf16 v[140:143], v[76:79], a[8:11], 0
    ds_read_b128 v[36:39], v21 offset:6144
    ds_read_b128 v[40:43], v20 offset:10240
    v_mfma_f32_16x16x32_bf16 v[180:183], v[80:83], a[8:11], 0
    ds_read_b128 a[40:43], v22 offset:10240
    ds_read_b128 a[44:47], v22 offset:11264
    v_mfma_f32_16x16x32_bf16 v[148:151], v[76:79], a[12:15], 0
    ds_read_b128 a[48:51], v22 offset:12288
    ds_read_b128 a[52:55], v22 offset:13312
    v_mfma_f32_16x16x32_bf16 v[188:191], v[80:83], a[12:15], 0
    ds_read_b128 a[56:59], v22 offset:14336
    v_mfma_f32_16x16x32_bf16 v[156:159], v[76:79], a[16:19], 0
    ds_read_b128 a[60:63], v22 offset:15360
    ds_read_b128 a[64:67], v22 offset:16384
    v_mfma_f32_16x16x32_bf16 v[196:199], v[80:83], a[16:19], 0
    ds_read_b128 a[68:71], v22 offset:17408
    ds_read_b128 a[72:75], v22 offset:18432
    v_mfma_f32_16x16x32_bf16 v[128:131], v[76:79], a[20:23], 0
    ds_read_b128 a[76:79], v22 offset:19456
    v_mfma_f32_16x16x32_bf16 v[168:171], v[80:83], a[20:23], 0
    s_waitcnt lgkmcnt(12)
    v_swap_b32 v30, v32
    v_swap_b32 v31, v33
    v_mfma_f32_16x16x32_bf16 v[136:139], v[76:79], a[24:27], 0
    s_waitcnt lgkmcnt(10)
    v_swap_b32 v38, v40
    v_swap_b32 v39, v41
    v_mfma_f32_16x16x32_bf16 v[176:179], v[80:83], a[24:27], 0
    s_add_u32 m0, s27, 2048
    s_nop 0
    buffer_load_dwordx4 v12, s[28:31], s72 offen lds
    v_add_u32 v223, 4096, v223
    buffer_store_dwordx4 v[232:235], v223, s[44:47], 0 offen offset:0 sc1
    v_mfma_f32_16x16x32_bf16 v[60:63], v[236:239], v[28:31], 0
    v_mfma_f32_16x16x32_bf16 v[64:67], v[236:239], v[32:35], 0
    v_mfma_f32_16x16x32_bf16 v[68:71], v[236:239], v[36:39], 0
    v_mfma_f32_16x16x32_bf16 v[72:75], v[236:239], v[40:43], 0
    v_mfma_f32_16x16x32_bf16 v[144:147], v[76:79], a[28:31], 0
    s_add_u32 m0, s27, 3072
    s_nop 0
    buffer_load_dwordx4 v13, s[28:31], s72 offen lds
    v_mfma_f32_16x16x32_bf16 v[184:187], v[80:83], a[28:31], 0
    v_mfma_f32_16x16x32_bf16 v[152:155], v[76:79], a[32:35], 0
    v_mfma_f32_16x16x32_bf16 v[192:195], v[80:83], a[32:35], 0
    v_cvt_pk_bf16_f32 v84, v60, v61
    v_cvt_pk_bf16_f32 v85, v62, v63
    v_cvt_pk_bf16_f32 v86, v64, v65
    v_cvt_pk_bf16_f32 v87, v66, v67
    v_mfma_f32_16x16x32_bf16 v[160:163], v[76:79], a[36:39], 0
    v_cvt_pk_bf16_f32 v88, v68, v69
    v_cvt_pk_bf16_f32 v89, v70, v71
    v_cvt_pk_bf16_f32 v90, v72, v73
    v_cvt_pk_bf16_f32 v91, v74, v75
    v_mfma_f32_16x16x32_bf16 v[200:203], v[80:83], a[36:39], 0
    s_waitcnt lgkmcnt(9)
    v_mfma_f32_16x16x32_bf16 v[124:127], v[84:87], a[40:43], v[124:127]
    s_add_u32 m0, s27, 4096
    s_nop 0
    buffer_load_dwordx4 v10, s[28:31], s77 offen lds
    buffer_store_dwordx4 v[232:235], v223, s[44:47], 0 offen offset:1024 sc1
    v_mfma_f32_16x16x32_bf16 v[164:167], v[88:91], a[40:43], v[164:167]
    s_waitcnt lgkmcnt(8)
    v_mfma_f32_16x16x32_bf16 v[132:135], v[84:87], a[44:47], v[132:135]
    s_add_u32 m0, s27, 5120
    s_nop 0
    buffer_load_dwordx4 v11, s[28:31], s77 offen lds
    v_mfma_f32_16x16x32_bf16 v[172:175], v[88:91], a[44:47], v[172:175]
    s_waitcnt vmcnt(16)
    s_barrier
    ds_read_b128 v[28:31], v20 offset:12288
    ds_read_b128 v[32:35], v21 offset:8192
    s_waitcnt lgkmcnt(9)
    v_mfma_f32_16x16x32_bf16 v[140:143], v[84:87], a[48:51], v[140:143]
    ds_read_b128 v[36:39], v20 offset:14336
    ds_read_b128 v[40:43], v21 offset:10240
    v_mfma_f32_16x16x32_bf16 v[180:183], v[88:91], a[48:51], v[180:183]
    ds_read_b128 a[0:3], v22 offset:20480
    ds_read_b128 a[4:7], v22 offset:21504
    s_waitcnt lgkmcnt(12)
    v_mfma_f32_16x16x32_bf16 v[148:151], v[84:87], a[52:55], v[148:151]
    ds_read_b128 a[8:11], v22 offset:22528
    ds_read_b128 a[12:15], v22 offset:23552
    v_mfma_f32_16x16x32_bf16 v[188:191], v[88:91], a[52:55], v[188:191]
    ds_read_b128 a[16:19], v22 offset:24576
    s_waitcnt lgkmcnt(14)
    v_mfma_f32_16x16x32_bf16 v[156:159], v[84:87], a[56:59], v[156:159]
    ds_read_b128 a[20:23], v22 offset:25600
    ds_read_b128 a[24:27], v22 offset:26624
    v_mfma_f32_16x16x32_bf16 v[196:199], v[88:91], a[56:59], v[196:199]
    ds_read_b128 a[28:31], v22 offset:27648
    ds_read_b128 a[32:35], v22 offset:28672
    s_waitcnt lgkmcnt(15)
    v_mfma_f32_16x16x32_bf16 v[128:131], v[84:87], a[60:63], v[128:131]
    ds_read_b128 a[36:39], v22 offset:29696
    v_mfma_f32_16x16x32_bf16 v[168:171], v[88:91], a[60:63], v[168:171]
    s_waitcnt lgkmcnt(12)
    v_swap_b32 v30, v32
    v_swap_b32 v31, v33
    v_mfma_f32_16x16x32_bf16 v[136:139], v[84:87], a[64:67], v[136:139]
    s_waitcnt lgkmcnt(10)
    v_swap_b32 v38, v40
    v_swap_b32 v39, v41
    v_mfma_f32_16x16x32_bf16 v[176:179], v[88:91], a[64:67], v[176:179]
    s_add_u32 m0, s27, 6144
    s_nop 0
    buffer_load_dwordx4 v12, s[28:31], s77 offen lds
    buffer_store_dwordx4 v[232:235], v223, s[44:47], 0 offen offset:2048 sc1
    v_mfma_f32_16x16x32_bf16 v[60:63], v[236:239], v[28:31], 0
    v_mfma_f32_16x16x32_bf16 v[64:67], v[236:239], v[32:35], 0
    v_mfma_f32_16x16x32_bf16 v[68:71], v[236:239], v[36:39], 0
    v_mfma_f32_16x16x32_bf16 v[72:75], v[236:239], v[40:43], 0
    v_mfma_f32_16x16x32_bf16 v[144:147], v[84:87], a[68:71], v[144:147]
    s_add_u32 m0, s27, 7168
    s_nop 0
    buffer_load_dwordx4 v13, s[28:31], s77 offen lds
    v_mfma_f32_16x16x32_bf16 v[184:187], v[88:91], a[68:71], v[184:187]
    ds_write_b128 v24, v[240:243]
    v_mfma_f32_16x16x32_bf16 v[152:155], v[84:87], a[72:75], v[152:155]
    v_mfma_f32_16x16x32_bf16 v[192:195], v[88:91], a[72:75], v[192:195]
    v_cvt_pk_bf16_f32 v76, v60, v61
    v_cvt_pk_bf16_f32 v77, v62, v63
    v_cvt_pk_bf16_f32 v78, v64, v65
    v_cvt_pk_bf16_f32 v79, v66, v67
    v_mfma_f32_16x16x32_bf16 v[160:163], v[84:87], a[76:79], v[160:163]
    v_cvt_pk_bf16_f32 v80, v68, v69
    v_cvt_pk_bf16_f32 v81, v70, v71
    v_cvt_pk_bf16_f32 v82, v72, v73
    v_cvt_pk_bf16_f32 v83, v74, v75
    v_mfma_f32_16x16x32_bf16 v[200:203], v[88:91], a[76:79], v[200:203]
    s_waitcnt lgkmcnt(10)
    v_mfma_f32_16x16x32_bf16 v[124:127], v[76:79], a[0:3], v[124:127]
    s_add_u32 m0, s27, 8192
    s_nop 0
    buffer_load_dwordx4 v10, s[28:31], s73 offen lds
    buffer_store_dwordx4 v[232:235], v223, s[44:47], 0 offen offset:3072 sc1
    v_mfma_f32_16x16x32_bf16 v[164:167], v[80:83], a[0:3], v[164:167]
    s_waitcnt lgkmcnt(9)
    v_mfma_f32_16x16x32_bf16 v[132:135], v[76:79], a[4:7], v[132:135]
    s_add_u32 m0, s27, 9216
    s_nop 0
    buffer_load_dwordx4 v11, s[28:31], s73 offen lds
    v_mfma_f32_16x16x32_bf16 v[172:175], v[80:83], a[4:7], v[172:175]
    s_waitcnt vmcnt(16)
    ds_read_b128 v[28:31], v21 offset:12288
    ds_read_b128 v[32:35], v20 offset:16384
    s_waitcnt lgkmcnt(10)
    v_mfma_f32_16x16x32_bf16 v[140:143], v[76:79], a[8:11], v[140:143]
    ds_read_b128 v[36:39], v21 offset:14336
    ds_read_b128 v[40:43], v20 offset:18432
    v_mfma_f32_16x16x32_bf16 v[180:183], v[80:83], a[8:11], v[180:183]
    ds_read_b128 a[40:43], v22 offset:30720
    ds_read_b128 a[44:47], v22 offset:31744
    s_waitcnt lgkmcnt(13)
    v_mfma_f32_16x16x32_bf16 v[148:151], v[76:79], a[12:15], v[148:151]
    ds_read_b128 a[48:51], v22 offset:32768
    ds_read_b128 a[52:55], v22 offset:33792
    v_mfma_f32_16x16x32_bf16 v[188:191], v[80:83], a[12:15], v[188:191]
    ds_read_b128 a[56:59], v22 offset:34816
    s_waitcnt lgkmcnt(15)
    v_mfma_f32_16x16x32_bf16 v[156:159], v[76:79], a[16:19], v[156:159]
    ds_read_b128 a[60:63], v22 offset:35840
    ds_read_b128 a[64:67], v22 offset:36864
    v_mfma_f32_16x16x32_bf16 v[196:199], v[80:83], a[16:19], v[196:199]
    ds_read_b128 a[68:71], v22 offset:37888
    ds_read_b128 a[72:75], v22 offset:38912
    s_waitcnt lgkmcnt(15)
    v_mfma_f32_16x16x32_bf16 v[128:131], v[76:79], a[20:23], v[128:131]
    ds_read_b128 a[76:79], v22 offset:39936
    v_mfma_f32_16x16x32_bf16 v[168:171], v[80:83], a[20:23], v[168:171]
    s_waitcnt lgkmcnt(12)
    v_swap_b32 v30, v32
    v_swap_b32 v31, v33
    v_mfma_f32_16x16x32_bf16 v[136:139], v[76:79], a[24:27], v[136:139]
    s_waitcnt lgkmcnt(10)
    v_swap_b32 v38, v40
    v_swap_b32 v39, v41
    v_mfma_f32_16x16x32_bf16 v[176:179], v[80:83], a[24:27], v[176:179]
    s_add_u32 m0, s27, 10240
    s_nop 0
    buffer_load_dwordx4 v12, s[28:31], s73 offen lds
    v_add_u32 v223, 4096, v223
    buffer_store_dwordx4 v[232:235], v223, s[44:47], 0 offen offset:0 sc1
    v_mfma_f32_16x16x32_bf16 v[60:63], v[236:239], v[28:31], 0
    v_mfma_f32_16x16x32_bf16 v[64:67], v[236:239], v[32:35], 0
    v_mfma_f32_16x16x32_bf16 v[68:71], v[236:239], v[36:39], 0
    v_mfma_f32_16x16x32_bf16 v[72:75], v[236:239], v[40:43], 0
    v_mfma_f32_16x16x32_bf16 v[144:147], v[76:79], a[28:31], v[144:147]
    s_add_u32 m0, s27, 11264
    s_nop 0
    buffer_load_dwordx4 v13, s[28:31], s73 offen lds
    v_mfma_f32_16x16x32_bf16 v[184:187], v[80:83], a[28:31], v[184:187]
    ds_write_b128 v24, v[244:247] offset:5120
    v_mfma_f32_16x16x32_bf16 v[152:155], v[76:79], a[32:35], v[152:155]
    v_mfma_f32_16x16x32_bf16 v[192:195], v[80:83], a[32:35], v[192:195]
    v_cvt_pk_bf16_f32 v84, v60, v61
    v_cvt_pk_bf16_f32 v85, v62, v63
    v_cvt_pk_bf16_f32 v86, v64, v65
    v_cvt_pk_bf16_f32 v87, v66, v67
    v_mfma_f32_16x16x32_bf16 v[160:163], v[76:79], a[36:39], v[160:163]
    v_cvt_pk_bf16_f32 v88, v68, v69
    v_cvt_pk_bf16_f32 v89, v70, v71
    v_cvt_pk_bf16_f32 v90, v72, v73
    v_cvt_pk_bf16_f32 v91, v74, v75
    v_mfma_f32_16x16x32_bf16 v[200:203], v[80:83], a[36:39], v[200:203]
    s_waitcnt lgkmcnt(10)
    v_mfma_f32_16x16x32_bf16 v[124:127], v[84:87], a[40:43], v[124:127]
    s_add_u32 m0, s27, 12288
    s_nop 0
    buffer_load_dwordx4 v10, s[28:31], s78 offen lds
    buffer_store_dwordx4 v[232:235], v231, s[44:47], 0 offen sc1
    v_mfma_f32_16x16x32_bf16 v[164:167], v[88:91], a[40:43], v[164:167]
    s_waitcnt lgkmcnt(9)
    v_mfma_f32_16x16x32_bf16 v[132:135], v[84:87], a[44:47], v[132:135]
    s_add_u32 m0, s27, 13312
    s_nop 0
    buffer_load_dwordx4 v11, s[28:31], s78 offen lds
    v_mfma_f32_16x16x32_bf16 v[172:175], v[88:91], a[44:47], v[172:175]
    s_waitcnt vmcnt(15)
    ds_read_b128 v[28:31], v20 offset:0
    ds_read_b128 v[32:35], v21 offset:16384
    s_waitcnt lgkmcnt(10)
    v_mfma_f32_16x16x32_bf16 v[140:143], v[84:87], a[48:51], v[140:143]
    ds_read_b128 v[36:39], v20 offset:2048
    ds_read_b128 v[40:43], v21 offset:18432
    v_mfma_f32_16x16x32_bf16 v[180:183], v[88:91], a[48:51], v[180:183]
    ds_read_b128 a[0:3], v23 offset:0
    ds_read_b128 a[4:7], v23 offset:1024
    s_waitcnt lgkmcnt(13)
    v_mfma_f32_16x16x32_bf16 v[148:151], v[84:87], a[52:55], v[148:151]
    ds_read_b128 a[8:11], v23 offset:2048
    ds_read_b128 a[12:15], v23 offset:3072
    v_mfma_f32_16x16x32_bf16 v[188:191], v[88:91], a[52:55], v[188:191]
    ds_read_b128 a[16:19], v23 offset:4096
    s_waitcnt lgkmcnt(15)
    v_mfma_f32_16x16x32_bf16 v[156:159], v[84:87], a[56:59], v[156:159]
    ds_read_b128 a[20:23], v23 offset:5120
    ds_read_b128 a[24:27], v23 offset:6144
    v_mfma_f32_16x16x32_bf16 v[196:199], v[88:91], a[56:59], v[196:199]
    ds_read_b128 a[28:31], v23 offset:7168
    ds_read_b128 a[32:35], v23 offset:8192
    s_waitcnt lgkmcnt(15)
    v_mfma_f32_16x16x32_bf16 v[128:131], v[84:87], a[60:63], v[128:131]
    ds_read_b128 a[36:39], v23 offset:9216
    v_mfma_f32_16x16x32_bf16 v[168:171], v[88:91], a[60:63], v[168:171]
    s_waitcnt lgkmcnt(12)
    v_swap_b32 v30, v32
    v_swap_b32 v31, v33
    v_mfma_f32_16x16x32_bf16 v[136:139], v[84:87], a[64:67], v[136:139]
    s_waitcnt lgkmcnt(10)
    v_swap_b32 v38, v40
    v_swap_b32 v39, v41
    v_mfma_f32_16x16x32_bf16 v[176:179], v[88:91], a[64:67], v[176:179]
    s_add_u32 m0, s27, 14336
    s_nop 0
    buffer_load_dwordx4 v12, s[28:31], s78 offen lds
    v_mfma_f32_16x16x32_bf16 v[60:63], v[236:239], v[28:31], 0
    v_mfma_f32_16x16x32_bf16 v[64:67], v[236:239], v[32:35], 0
    s_add_u32 m0, s27, 15360
    s_nop 0
    buffer_load_dwordx4 v13, s[28:31], s78 offen lds
    v_mfma_f32_16x16x32_bf16 v[68:71], v[236:239], v[36:39], 0
    v_mfma_f32_16x16x32_bf16 v[72:75], v[236:239], v[40:43], 0
    v_mfma_f32_16x16x32_bf16 v[144:147], v[84:87], a[68:71], v[144:147]
    buffer_load_dword v229, v229, s[36:39], 0 offen
    v_mfma_f32_16x16x32_bf16 v[184:187], v[88:91], a[68:71], v[184:187]
    ds_write_b128 v22, v[248:251] offset:4096
    v_mfma_f32_16x16x32_bf16 v[152:155], v[84:87], a[72:75], v[152:155]
    ds_write_b128 v22, v[252:255] offset:9216
    v_mfma_f32_16x16x32_bf16 v[192:195], v[88:91], a[72:75], v[192:195]
    v_cvt_pk_bf16_f32 v76, v60, v61
    v_cvt_pk_bf16_f32 v77, v62, v63
    v_cvt_pk_bf16_f32 v78, v64, v65
    v_cvt_pk_bf16_f32 v79, v66, v67
    v_mfma_f32_16x16x32_bf16 v[160:163], v[84:87], a[76:79], v[160:163]
    v_cvt_pk_bf16_f32 v80, v68, v69
    v_cvt_pk_bf16_f32 v81, v70, v71
    v_cvt_pk_bf16_f32 v82, v72, v73
    v_cvt_pk_bf16_f32 v83, v74, v75
    v_mfma_f32_16x16x32_bf16 v[200:203], v[88:91], a[76:79], v[200:203]
    s_waitcnt lgkmcnt(11)
    v_mfma_f32_16x16x32_bf16 v[124:127], v[76:79], a[0:3], v[124:127]
    v_mfma_f32_16x16x32_bf16 v[164:167], v[80:83], a[0:3], v[164:167]
    s_waitcnt lgkmcnt(10)
    v_mfma_f32_16x16x32_bf16 v[132:135], v[76:79], a[4:7], v[132:135]
    v_mfma_f32_16x16x32_bf16 v[172:175], v[80:83], a[4:7], v[172:175]
    s_waitcnt vmcnt(4) lgkmcnt(0)
    s_barrier
    buffer_store_byte v232, v222, s[52:55], 0 offen sc1
    ds_read_b128 v[28:31], v21 offset:0
    ds_read_b128 v[32:35], v20 offset:4096
    v_mfma_f32_16x16x32_bf16 v[140:143], v[76:79], a[8:11], v[140:143]
    ds_read_b128 v[36:39], v21 offset:2048
    ds_read_b128 v[40:43], v20 offset:6144
    v_mfma_f32_16x16x32_bf16 v[180:183], v[80:83], a[8:11], v[180:183]
    ds_read_b128 a[40:43], v23 offset:10240
    ds_read_b128 a[44:47], v23 offset:11264
    v_mfma_f32_16x16x32_bf16 v[148:151], v[76:79], a[12:15], v[148:151]
    ds_read_b128 a[48:51], v23 offset:12288
    ds_read_b128 a[52:55], v23 offset:13312
    v_mfma_f32_16x16x32_bf16 v[188:191], v[80:83], a[12:15], v[188:191]
    ds_read_b128 a[56:59], v23 offset:14336
    v_mfma_f32_16x16x32_bf16 v[156:159], v[76:79], a[16:19], v[156:159]
    ds_read_b128 a[60:63], v23 offset:15360
    ds_read_b128 a[64:67], v23 offset:16384
    v_mfma_f32_16x16x32_bf16 v[196:199], v[80:83], a[16:19], v[196:199]
    ds_read_b128 a[68:71], v23 offset:17408
    ds_read_b128 a[72:75], v23 offset:18432
    v_mfma_f32_16x16x32_bf16 v[128:131], v[76:79], a[20:23], v[128:131]
    ds_read_b128 a[76:79], v23 offset:19456
    v_mfma_f32_16x16x32_bf16 v[168:171], v[80:83], a[20:23], v[168:171]
    s_waitcnt lgkmcnt(12)
    v_swap_b32 v30, v32
    v_swap_b32 v31, v33
    v_mfma_f32_16x16x32_bf16 v[136:139], v[76:79], a[24:27], v[136:139]
    s_waitcnt lgkmcnt(10)
    v_swap_b32 v38, v40
    v_swap_b32 v39, v41
    v_mfma_f32_16x16x32_bf16 v[176:179], v[80:83], a[24:27], v[176:179]
    v_mfma_f32_16x16x32_bf16 v[60:63], v[236:239], v[28:31], 0
    v_mfma_f32_16x16x32_bf16 v[64:67], v[236:239], v[32:35], 0
    v_mfma_f32_16x16x32_bf16 v[68:71], v[236:239], v[36:39], 0
    v_mfma_f32_16x16x32_bf16 v[72:75], v[236:239], v[40:43], 0
    v_mfma_f32_16x16x32_bf16 v[144:147], v[76:79], a[28:31], v[144:147]
    v_mfma_f32_16x16x32_bf16 v[184:187], v[80:83], a[28:31], v[184:187]
    v_mfma_f32_16x16x32_bf16 v[152:155], v[76:79], a[32:35], v[152:155]
    v_mfma_f32_16x16x32_bf16 v[192:195], v[80:83], a[32:35], v[192:195]
    s_nop 0
    v_cvt_pk_bf16_f32 v84, v60, v61
    v_cvt_pk_bf16_f32 v85, v62, v63
    v_cvt_pk_bf16_f32 v86, v64, v65
    v_cvt_pk_bf16_f32 v87, v66, v67
    v_mfma_f32_16x16x32_bf16 v[160:163], v[76:79], a[36:39], v[160:163]
    v_cvt_pk_bf16_f32 v88, v68, v69
    v_cvt_pk_bf16_f32 v89, v70, v71
    v_cvt_pk_bf16_f32 v90, v72, v73
    v_cvt_pk_bf16_f32 v91, v74, v75
    v_mfma_f32_16x16x32_bf16 v[200:203], v[80:83], a[36:39], v[200:203]
    s_waitcnt lgkmcnt(9)
    v_mfma_f32_16x16x32_bf16 v[124:127], v[84:87], a[40:43], v[124:127]
    v_mfma_f32_16x16x32_bf16 v[164:167], v[88:91], a[40:43], v[164:167]
    s_waitcnt lgkmcnt(8)
    v_mfma_f32_16x16x32_bf16 v[132:135], v[84:87], a[44:47], v[132:135]
    v_mfma_f32_16x16x32_bf16 v[172:175], v[88:91], a[44:47], v[172:175]
    s_waitcnt vmcnt(7)
    ds_read_b128 v[28:31], v20 offset:8192
    ds_read_b128 v[32:35], v21 offset:4096
    s_waitcnt lgkmcnt(9)
    v_mfma_f32_16x16x32_bf16 v[140:143], v[84:87], a[48:51], v[140:143]
    ds_read_b128 v[36:39], v20 offset:10240
    ds_read_b128 v[40:43], v21 offset:6144
    v_mfma_f32_16x16x32_bf16 v[180:183], v[88:91], a[48:51], v[180:183]
    ds_read_b128 a[0:3], v23 offset:20480
    ds_read_b128 a[4:7], v23 offset:21504
    s_waitcnt lgkmcnt(12)
    v_mfma_f32_16x16x32_bf16 v[148:151], v[84:87], a[52:55], v[148:151]
    ds_read_b128 a[8:11], v23 offset:22528
    ds_read_b128 a[12:15], v23 offset:23552
    v_mfma_f32_16x16x32_bf16 v[188:191], v[88:91], a[52:55], v[188:191]
    ds_read_b128 a[16:19], v23 offset:24576
    s_waitcnt lgkmcnt(14)
    v_mfma_f32_16x16x32_bf16 v[156:159], v[84:87], a[56:59], v[156:159]
    ds_read_b128 a[20:23], v23 offset:25600
    ds_read_b128 a[24:27], v23 offset:26624
    v_mfma_f32_16x16x32_bf16 v[196:199], v[88:91], a[56:59], v[196:199]
    ds_read_b128 a[28:31], v23 offset:27648
    ds_read_b128 a[32:35], v23 offset:28672
    s_waitcnt lgkmcnt(15)
    v_mfma_f32_16x16x32_bf16 v[128:131], v[84:87], a[60:63], v[128:131]
    ds_read_b128 a[36:39], v23 offset:29696
    v_mfma_f32_16x16x32_bf16 v[168:171], v[88:91], a[60:63], v[168:171]
    s_waitcnt lgkmcnt(12)
    v_swap_b32 v30, v32
    v_swap_b32 v31, v33
    v_mfma_f32_16x16x32_bf16 v[136:139], v[84:87], a[64:67], v[136:139]
    s_waitcnt lgkmcnt(10)
    v_swap_b32 v38, v40
    v_swap_b32 v39, v41
    v_mfma_f32_16x16x32_bf16 v[176:179], v[88:91], a[64:67], v[176:179]
    v_mfma_f32_16x16x32_bf16 v[60:63], v[236:239], v[28:31], 0
    v_mfma_f32_16x16x32_bf16 v[64:67], v[236:239], v[32:35], 0
    v_mfma_f32_16x16x32_bf16 v[68:71], v[236:239], v[36:39], 0
    v_mfma_f32_16x16x32_bf16 v[72:75], v[236:239], v[40:43], 0
    v_mfma_f32_16x16x32_bf16 v[144:147], v[84:87], a[68:71], v[144:147]
    v_mfma_f32_16x16x32_bf16 v[184:187], v[88:91], a[68:71], v[184:187]
    v_mfma_f32_16x16x32_bf16 v[152:155], v[84:87], a[72:75], v[152:155]
    v_mfma_f32_16x16x32_bf16 v[192:195], v[88:91], a[72:75], v[192:195]
    s_nop 0
    v_cvt_pk_bf16_f32 v76, v60, v61
    v_cvt_pk_bf16_f32 v77, v62, v63
    v_cvt_pk_bf16_f32 v78, v64, v65
    v_cvt_pk_bf16_f32 v79, v66, v67
    v_mfma_f32_16x16x32_bf16 v[160:163], v[84:87], a[76:79], v[160:163]
    v_cvt_pk_bf16_f32 v80, v68, v69
    v_cvt_pk_bf16_f32 v81, v70, v71
    v_cvt_pk_bf16_f32 v82, v72, v73
    v_cvt_pk_bf16_f32 v83, v74, v75
    v_mfma_f32_16x16x32_bf16 v[200:203], v[88:91], a[76:79], v[200:203]
    s_waitcnt lgkmcnt(9)
    v_mfma_f32_16x16x32_bf16 v[124:127], v[76:79], a[0:3], v[124:127]
    v_mfma_f32_16x16x32_bf16 v[164:167], v[80:83], a[0:3], v[164:167]
    s_waitcnt lgkmcnt(8)
    v_mfma_f32_16x16x32_bf16 v[132:135], v[76:79], a[4:7], v[132:135]
    v_mfma_f32_16x16x32_bf16 v[172:175], v[80:83], a[4:7], v[172:175]
    s_waitcnt vmcnt(2)
    ds_read_b128 v[28:31], v21 offset:8192
    ds_read_b128 v[32:35], v20 offset:12288
    s_waitcnt lgkmcnt(9)
    v_mfma_f32_16x16x32_bf16 v[140:143], v[76:79], a[8:11], v[140:143]
    ds_read_b128 v[36:39], v21 offset:10240
    ds_read_b128 v[40:43], v20 offset:14336
    v_mfma_f32_16x16x32_bf16 v[180:183], v[80:83], a[8:11], v[180:183]
    ds_read_b128 a[40:43], v23 offset:30720
    ds_read_b128 a[44:47], v23 offset:31744
    s_waitcnt lgkmcnt(12)
    v_mfma_f32_16x16x32_bf16 v[148:151], v[76:79], a[12:15], v[148:151]
    ds_read_b128 a[48:51], v23 offset:32768
    ds_read_b128 a[52:55], v23 offset:33792
    v_mfma_f32_16x16x32_bf16 v[188:191], v[80:83], a[12:15], v[188:191]
    ds_read_b128 a[56:59], v23 offset:34816
    s_waitcnt lgkmcnt(14)
    v_mfma_f32_16x16x32_bf16 v[156:159], v[76:79], a[16:19], v[156:159]
    ds_read_b128 a[60:63], v23 offset:35840
    ds_read_b128 a[64:67], v23 offset:36864
    v_mfma_f32_16x16x32_bf16 v[196:199], v[80:83], a[16:19], v[196:199]
    ds_read_b128 a[68:71], v23 offset:37888
    ds_read_b128 a[72:75], v23 offset:38912
    s_waitcnt lgkmcnt(15)
    v_mfma_f32_16x16x32_bf16 v[128:131], v[76:79], a[20:23], v[128:131]
    ds_read_b128 a[76:79], v23 offset:39936
    v_mfma_f32_16x16x32_bf16 v[168:171], v[80:83], a[20:23], v[168:171]
    s_waitcnt lgkmcnt(12)
    v_swap_b32 v30, v32
    v_swap_b32 v31, v33
    v_mfma_f32_16x16x32_bf16 v[136:139], v[76:79], a[24:27], v[136:139]
    s_waitcnt lgkmcnt(10)
    v_swap_b32 v38, v40
    v_swap_b32 v39, v41
    v_mfma_f32_16x16x32_bf16 v[176:179], v[80:83], a[24:27], v[176:179]
    v_mfma_f32_16x16x32_bf16 v[60:63], v[236:239], v[28:31], 0
    v_mfma_f32_16x16x32_bf16 v[64:67], v[236:239], v[32:35], 0
    v_mfma_f32_16x16x32_bf16 v[68:71], v[236:239], v[36:39], 0
    v_mfma_f32_16x16x32_bf16 v[72:75], v[236:239], v[40:43], 0
    v_mfma_f32_16x16x32_bf16 v[144:147], v[76:79], a[28:31], v[144:147]
    v_mfma_f32_16x16x32_bf16 v[184:187], v[80:83], a[28:31], v[184:187]
    v_mfma_f32_16x16x32_bf16 v[152:155], v[76:79], a[32:35], v[152:155]
    v_mfma_f32_16x16x32_bf16 v[192:195], v[80:83], a[32:35], v[192:195]
    s_nop 0
    v_cvt_pk_bf16_f32 v84, v60, v61
    v_cvt_pk_bf16_f32 v85, v62, v63
    v_cvt_pk_bf16_f32 v86, v64, v65
    v_cvt_pk_bf16_f32 v87, v66, v67
    v_mfma_f32_16x16x32_bf16 v[160:163], v[76:79], a[36:39], v[160:163]
    v_cvt_pk_bf16_f32 v88, v68, v69
    v_cvt_pk_bf16_f32 v89, v70, v71
    v_cvt_pk_bf16_f32 v90, v72, v73
    v_cvt_pk_bf16_f32 v91, v74, v75
    v_mfma_f32_16x16x32_bf16 v[200:203], v[80:83], a[36:39], v[200:203]
    s_waitcnt lgkmcnt(9)
    v_mfma_f32_16x16x32_bf16 v[124:127], v[84:87], a[40:43], v[124:127]
    v_mfma_f32_16x16x32_bf16 v[164:167], v[88:91], a[40:43], v[164:167]
    s_waitcnt lgkmcnt(8)
    v_mfma_f32_16x16x32_bf16 v[132:135], v[84:87], a[44:47], v[132:135]
    v_mfma_f32_16x16x32_bf16 v[172:175], v[88:91], a[44:47], v[172:175]
    s_waitcnt vmcnt(2)
    ds_read_b128 v[48:51], v21 offset:12288
    ds_read_b128 v[56:59], v21 offset:14336
    s_waitcnt lgkmcnt(9)
    v_mfma_f32_16x16x32_bf16 v[140:143], v[84:87], a[48:51], v[140:143]
    ds_read_b128 a[0:3], v22 offset:0
    ds_read_b128 a[4:7], v22 offset:1024
    v_mfma_f32_16x16x32_bf16 v[180:183], v[88:91], a[48:51], v[180:183]
    ds_read_b128 a[8:11], v22 offset:2048
    s_waitcnt lgkmcnt(11)
    v_mfma_f32_16x16x32_bf16 v[148:151], v[84:87], a[52:55], v[148:151]
    ds_read_b128 a[12:15], v22 offset:3072
    ds_read_b128 a[16:19], v22 offset:4096
    v_mfma_f32_16x16x32_bf16 v[188:191], v[88:91], a[52:55], v[188:191]
    ds_read_b128 a[20:23], v22 offset:5120
    s_waitcnt lgkmcnt(13)
    v_mfma_f32_16x16x32_bf16 v[156:159], v[84:87], a[56:59], v[156:159]
    ds_read_b128 a[24:27], v22 offset:6144
    ds_read_b128 a[28:31], v22 offset:7168
    v_mfma_f32_16x16x32_bf16 v[196:199], v[88:91], a[56:59], v[196:199]
    ds_read_b128 a[32:35], v22 offset:8192
    s_waitcnt lgkmcnt(15)
    v_mfma_f32_16x16x32_bf16 v[128:131], v[84:87], a[60:63], v[128:131]
    ds_read_b128 a[36:39], v22 offset:9216
    v_mfma_f32_16x16x32_bf16 v[168:171], v[88:91], a[60:63], v[168:171]
    s_waitcnt lgkmcnt(11)
    v_swap_b32 v46, v48
    v_swap_b32 v47, v49
    v_mfma_f32_16x16x32_bf16 v[136:139], v[84:87], a[64:67], v[136:139]
    s_waitcnt lgkmcnt(10)
    v_swap_b32 v54, v56
    v_swap_b32 v55, v57
    v_mfma_f32_16x16x32_bf16 v[176:179], v[88:91], a[64:67], v[176:179]
    v_mfma_f32_16x16x32_bf16 v[60:63], v[236:239], v[44:47], 0
    v_mfma_f32_16x16x32_bf16 v[64:67], v[236:239], v[48:51], 0
    v_mfma_f32_16x16x32_bf16 v[68:71], v[236:239], v[52:55], 0
    v_mfma_f32_16x16x32_bf16 v[72:75], v[236:239], v[56:59], 0
    v_mfma_f32_16x16x32_bf16 v[144:147], v[84:87], a[68:71], v[144:147]
    v_mfma_f32_16x16x32_bf16 v[184:187], v[88:91], a[68:71], v[184:187]
    v_mfma_f32_16x16x32_bf16 v[152:155], v[84:87], a[72:75], v[152:155]
    v_mfma_f32_16x16x32_bf16 v[192:195], v[88:91], a[72:75], v[192:195]
    s_nop 0
    v_cvt_pk_bf16_f32 v76, v60, v61
    v_cvt_pk_bf16_f32 v77, v62, v63
    v_cvt_pk_bf16_f32 v78, v64, v65
    v_cvt_pk_bf16_f32 v79, v66, v67
    v_mfma_f32_16x16x32_bf16 v[160:163], v[84:87], a[76:79], v[160:163]
    v_cvt_pk_bf16_f32 v80, v68, v69
    v_cvt_pk_bf16_f32 v81, v70, v71
    v_cvt_pk_bf16_f32 v82, v72, v73
    v_cvt_pk_bf16_f32 v83, v74, v75
    v_mfma_f32_16x16x32_bf16 v[200:203], v[88:91], a[76:79], v[200:203]
    s_waitcnt lgkmcnt(9)
    v_mfma_f32_16x16x32_bf16 v[124:127], v[76:79], a[0:3], v[124:127]
    buffer_load_dword v11, v230, s[52:55], 0 offen sc1
    v_mfma_f32_16x16x32_bf16 v[164:167], v[80:83], a[0:3], v[164:167]
    s_waitcnt lgkmcnt(4)
    v_mfma_f32_16x16x32_bf16 v[128:131], v[76:79], a[20:23], v[128:131]
    v_mfma_f32_16x16x32_bf16 v[168:171], v[80:83], a[20:23], v[168:171]
    v_mfma_f32_16x16x32_bf16 v[132:135], v[76:79], a[4:7], v[132:135]
    v_mfma_f32_16x16x32_bf16 v[172:175], v[80:83], a[4:7], v[172:175]
    s_waitcnt lgkmcnt(3)
    v_mfma_f32_16x16x32_bf16 v[136:139], v[76:79], a[24:27], v[136:139]
    v_cvt_pk_bf16_f32 v28, v124, v125
    v_mfma_f32_16x16x32_bf16 v[176:179], v[80:83], a[24:27], v[176:179]
    v_cvt_pk_bf16_f32 v29, v126, v127
    v_cvt_pk_bf16_f32 v32, v164, v165
    v_mfma_f32_16x16x32_bf16 v[156:159], v[76:79], a[16:19], v[156:159]
    v_cvt_pk_bf16_f32 v30, v128, v129
    v_cvt_pk_bf16_f32 v31, v130, v131
    v_mfma_f32_16x16x32_bf16 v[196:199], v[80:83], a[16:19], v[196:199]
    v_cvt_pk_bf16_f32 v33, v166, v167
    v_cvt_pk_bf16_f32 v34, v168, v169
    s_waitcnt lgkmcnt(0)
    v_mfma_f32_16x16x32_bf16 v[160:163], v[76:79], a[36:39], v[160:163]
    v_cvt_pk_bf16_f32 v35, v170, v171
    v_cvt_pk_bf16_f32 v36, v132, v133
    v_mfma_f32_16x16x32_bf16 v[200:203], v[80:83], a[36:39], v[200:203]
    v_cvt_pk_bf16_f32 v37, v134, v135
    v_cvt_pk_bf16_f32 v38, v136, v137
    v_mfma_f32_16x16x32_bf16 v[140:143], v[76:79], a[8:11], v[140:143]
    v_cvt_pk_bf16_f32 v39, v138, v139
    v_cvt_pk_bf16_f32 v40, v172, v173
    v_mfma_f32_16x16x32_bf16 v[180:183], v[80:83], a[8:11], v[180:183]
    v_cvt_pk_bf16_f32 v41, v174, v175
    v_cvt_pk_bf16_f32 v42, v176, v177
    v_mfma_f32_16x16x32_bf16 v[144:147], v[76:79], a[28:31], v[144:147]
    v_cvt_pk_bf16_f32 v43, v178, v179
    v_cvt_pk_bf16_f32 v60, v156, v157
    v_mfma_f32_16x16x32_bf16 v[184:187], v[80:83], a[28:31], v[184:187]
    v_cvt_pk_bf16_f32 v61, v158, v159
    v_cvt_pk_bf16_f32 v62, v160, v161
    v_mfma_f32_16x16x32_bf16 v[148:151], v[76:79], a[12:15], v[148:151]
    v_cvt_pk_bf16_f32 v63, v162, v163
    v_cvt_pk_bf16_f32 v64, v196, v197
    v_mfma_f32_16x16x32_bf16 v[188:191], v[80:83], a[12:15], v[188:191]
    v_cvt_pk_bf16_f32 v65, v198, v199
    v_cvt_pk_bf16_f32 v66, v200, v201
    v_mfma_f32_16x16x32_bf16 v[152:155], v[76:79], a[32:35], v[152:155]
    v_cvt_pk_bf16_f32 v67, v202, v203
    v_cvt_pk_bf16_f32 v44, v140, v141
    v_mfma_f32_16x16x32_bf16 v[192:195], v[80:83], a[32:35], v[192:195]
    v_cvt_pk_bf16_f32 v45, v142, v143
    v_cvt_pk_bf16_f32 v46, v144, v145
    v_mfma_f32_16x16x32_bf16 v[124:127], v[204:207], v[28:31], 0
    v_cvt_pk_bf16_f32 v47, v146, v147
    v_cvt_pk_bf16_f32 v48, v180, v181
    v_mfma_f32_16x16x32_bf16 v[128:131], v[206:209], v[28:31], 0
    v_cvt_pk_bf16_f32 v49, v182, v183
    v_cvt_pk_bf16_f32 v50, v184, v185
    v_mfma_f32_16x16x32_bf16 v[164:167], v[204:207], v[32:35], 0
    v_cvt_pk_bf16_f32 v51, v186, v187
    v_cvt_pk_bf16_f32 v52, v148, v149
    v_mfma_f32_16x16x32_bf16 v[168:171], v[206:209], v[32:35], 0
    v_cvt_pk_bf16_f32 v53, v150, v151
    v_cvt_pk_bf16_f32 v54, v152, v153
    v_mfma_f32_16x16x32_bf16 v[132:135], v[204:207], v[36:39], 0
    v_cvt_pk_bf16_f32 v55, v154, v155
    v_cvt_pk_bf16_f32 v56, v188, v189
    v_mfma_f32_16x16x32_bf16 v[136:139], v[206:209], v[36:39], 0
    v_cvt_pk_bf16_f32 v57, v190, v191
    v_cvt_pk_bf16_f32 v58, v192, v193
    v_mfma_f32_16x16x32_bf16 v[172:175], v[204:207], v[40:43], 0
    v_cvt_pk_bf16_f32 v59, v194, v195
    v_cvt_pk_bf16_f32 v76, v124, v164
    v_mfma_f32_16x16x32_bf16 v[176:179], v[206:209], v[40:43], 0
    v_cvt_pk_bf16_f32 v77, v128, v168
    v_cvt_pk_bf16_f32 v80, v125, v165
    v_mfma_f32_16x16x32_bf16 v[156:159], v[204:207], v[60:63], 0
    v_cvt_pk_bf16_f32 v81, v129, v169
    v_cvt_pk_bf16_f32 v84, v126, v166
    v_mfma_f32_16x16x32_bf16 v[160:163], v[206:209], v[60:63], 0
    v_cvt_pk_bf16_f32 v78, v132, v172
    v_cvt_pk_bf16_f32 v82, v133, v173
    v_mfma_f32_16x16x32_bf16 v[196:199], v[204:207], v[64:67], 0
    v_cvt_pk_bf16_f32 v79, v136, v176
    buffer_store_dwordx4 v[76:79], v26, s[44:47], 0 offen offset:0 sc1
    v_mfma_f32_16x16x32_bf16 v[200:203], v[206:209], v[64:67], 0
    v_cvt_pk_bf16_f32 v83, v137, v177
    v_cvt_pk_bf16_f32 v85, v130, v170
    v_mfma_f32_16x16x32_bf16 v[140:143], v[204:207], v[44:47], 0
    buffer_store_dwordx4 v[80:83], v26, s[44:47], s97 offen offset:0 sc1
    v_cvt_pk_bf16_f32 v86, v134, v174
    v_mfma_f32_16x16x32_bf16 v[144:147], v[206:209], v[44:47], 0
    v_cvt_pk_bf16_f32 v87, v138, v178
    v_cvt_pk_bf16_f32 v88, v127, v167
    v_mfma_f32_16x16x32_bf16 v[180:183], v[204:207], v[48:51], 0
    v_cvt_pk_bf16_f32 v89, v131, v171
    buffer_store_dwordx4 v[84:87], v26, s[44:47], s98 offen offset:0 sc1
    v_mfma_f32_16x16x32_bf16 v[184:187], v[206:209], v[48:51], 0
    v_cvt_pk_bf16_f32 v90, v135, v175
    v_cvt_pk_bf16_f32 v91, v139, v179
    v_mfma_f32_16x16x32_bf16 v[148:151], v[204:207], v[52:55], 0
    buffer_store_dwordx4 v[88:91], v26, s[44:47], s99 offen offset:0 sc1
    v_cvt_pk_bf16_f32 v108, v156, v196
    v_mfma_f32_16x16x32_bf16 v[152:155], v[206:209], v[52:55], 0
    v_cvt_pk_bf16_f32 v109, v160, v200
    buffer_store_dwordx2 v[108:109], v210, s[44:47], 0 offen offset:512 sc1
    v_mfma_f32_16x16x32_bf16 v[188:191], v[204:207], v[56:59], 0
    v_cvt_pk_bf16_f32 v110, v157, v197
    v_cvt_pk_bf16_f32 v111, v161, v201
    v_mfma_f32_16x16x32_bf16 v[192:195], v[206:209], v[56:59], 0
    buffer_store_dwordx2 v[110:111], v210, s[44:47], s97 offen offset:512 sc1
    v_cvt_pk_bf16_f32 v112, v158, v198
    v_cvt_pk_bf16_f32 v113, v162, v202
    buffer_store_dwordx2 v[112:113], v210, s[44:47], s98 offen offset:512 sc1
    v_cvt_pk_bf16_f32 v114, v159, v199
    v_cvt_pk_bf16_f32 v115, v163, v203
    buffer_store_dwordx2 v[114:115], v210, s[44:47], s99 offen offset:512 sc1
    v_cvt_pk_bf16_f32 v92, v140, v180
    v_cvt_pk_bf16_f32 v93, v144, v184
    v_cvt_pk_bf16_f32 v94, v148, v188
    v_cvt_pk_bf16_f32 v95, v152, v192
    v_cvt_pk_bf16_f32 v96, v141, v181
    v_cvt_pk_bf16_f32 v97, v145, v185
    buffer_store_dwordx4 v[92:95], v26, s[44:47], 0 offen offset:256 sc1
    v_cvt_pk_bf16_f32 v98, v149, v189
    v_cvt_pk_bf16_f32 v99, v153, v193
    v_cvt_pk_bf16_f32 v100, v142, v182
    v_cvt_pk_bf16_f32 v101, v146, v186
    buffer_store_dwordx4 v[96:99], v26, s[44:47], s97 offen offset:256 sc1
    v_cvt_pk_bf16_f32 v102, v150, v190
    v_cvt_pk_bf16_f32 v103, v154, v194
    v_cvt_pk_bf16_f32 v104, v143, v183
    v_cvt_pk_bf16_f32 v105, v147, v187
    buffer_store_dwordx4 v[100:103], v26, s[44:47], s98 offen offset:256 sc1
    v_cvt_pk_bf16_f32 v106, v151, v191
    v_cvt_pk_bf16_f32 v107, v155, v195
    buffer_store_dwordx4 v[104:107], v26, s[44:47], s99 offen offset:256 sc1
    s_lshl_b32 s101, s57, 1
    s_lshr_b32 s61, s58, 2
    s_add_u32 s101, s101, s61
    s_and_b32 s100, s58, 3
    s_mul_i32 s62, s101, 163840
    s_mul_i32 s63, s100, 40960
    s_add_u32 s62, s62, s63
    s_lshl_b32 s3, s56, 10
    s_add_u32 s62, s62, s3
    s_add_u32 s62, s62, 2621440
    v_lshl_add_u32 v228, v0, 4, s62
    s_lshr_b32 s62, s100, 1
    s_lshl_b32 s62, s62, 2
    s_add_u32 s62, s62, s56
    s_lshl_b32 s62, s62, 9
    s_add_u32 s62, s62, 2392064
    v_and_b32 v3, 31, v0
    v_lshl_add_u32 v221, v3, 4, s62
    s_mul_i32 s62, s56, 9216
    s_add_u32 s62, s62, 40960
    v_mul_u32_u24 v3, 144, v1
    v_mul_u32_u24 v4, 36, v2
    v_add3_u32 v224, v3, v4, s62
    v_sub_u32 v4, 2412, v4
    v_add3_u32 v225, v3, v4, s62
    v_lshl_add_u32 v226, v0, 4, s62
    v_mul_u32_u24 v3, 640, v2
    v_lshrrev_b32 v4, 1, v1
    v_and_b32 v5, 1, v1
    v_lshl_add_u32 v4, v5, 3, v4
    v_lshl_add_u32 v227, v4, 3, v3
    v_lshl_add_u32 v3, v4, 4, v3
    v_and_b32 v4, 1, v2
    v_lshl_add_u32 v14, v4, 3, v3
    v_xor_b32 v15, 8, v14
    s_lshl_b32 s61, s56, 9
    s_add_u32 s61, s61, s101
    v_lshl_add_u32 v3, v1, 4, s61
    v_cvt_f32_u32 v3, v3
    v_lshlrev_b32 v4, 3, v2
    v_cvt_f32_u32 v4, v4
    v_mul_f32 v3, 0x3a000000, v3
    v_cos_f32 v5, v3
    v_mul_f32 v6, v3, v4
    v_add_f32 v5, v5, v5
    v_mov_b32 v7, v6
    v_add_f32 v8, v7, v3
    v_cos_f32 v164, v7
    v_sin_f32 v172, -v7
    v_cos_f32 v165, v8
    v_sin_f32 v173, -v8
    v_fmamk_f32 v7, v3, 0x42000000, v6
    v_add_f32 v8, v7, v3
    v_cos_f32 v180, v7
    v_sin_f32 v188, -v7
    v_cos_f32 v181, v8
    v_sin_f32 v189, -v8
    v_fma_f32 v166, v5, v165, -v164
    v_fma_f32 v174, v5, v173, -v172
    v_fma_f32 v182, v5, v181, -v180
    v_fma_f32 v190, v5, v189, -v188
    v_fma_f32 v167, v5, v166, -v165
    v_fma_f32 v175, v5, v174, -v173
    v_fma_f32 v183, v5, v182, -v181
    v_fma_f32 v191, v5, v190, -v189
    v_fma_f32 v168, v5, v167, -v166
    v_fma_f32 v176, v5, v175, -v174
    v_fma_f32 v184, v5, v183, -v182
    v_fma_f32 v192, v5, v191, -v190
    v_fma_f32 v169, v5, v168, -v167
    v_fma_f32 v177, v5, v176, -v175
    v_fma_f32 v185, v5, v184, -v183
    v_fma_f32 v193, v5, v192, -v191
    v_fma_f32 v170, v5, v169, -v168
    v_fma_f32 v178, v5, v177, -v176
    v_fma_f32 v186, v5, v185, -v184
    v_fma_f32 v194, v5, v193, -v192
    v_fma_f32 v171, v5, v170, -v169
    v_fma_f32 v179, v5, v178, -v177
    v_fma_f32 v187, v5, v186, -v185
    v_fma_f32 v195, v5, v194, -v193
    v_cvt_pk_bf16_f32 v28, v164, v165
    v_cvt_pk_bf16_f32 v29, v172, v173
    v_cvt_pk_bf16_f32 v30, v168, v169
    v_cvt_pk_bf16_f32 v31, v176, v177
    v_cvt_pk_bf16_f32 v32, v166, v167
    v_cvt_pk_bf16_f32 v33, v174, v175
    v_cvt_pk_bf16_f32 v34, v170, v171
    v_cvt_pk_bf16_f32 v35, v178, v179
    v_cvt_pk_bf16_f32 v36, v180, v181
    v_mov_b32 v10, 0
    s_waitcnt vmcnt(0)
    buffer_store_dword v10, v220, s[44:47], 0 offen sc1
    v_cvt_pk_bf16_f32 v37, v188, v189
    v_cvt_pk_bf16_f32 v38, v184, v185
    v_cvt_pk_bf16_f32 v39, v192, v193
    v_cvt_pk_bf16_f32 v40, v182, v183
    v_cvt_pk_bf16_f32 v41, v190, v191
    v_cvt_pk_bf16_f32 v42, v186, v187
    v_cvt_pk_bf16_f32 v43, v194, v195
    v_fmamk_f32 v7, v3, 0x42800000, v6
    v_add_f32 v8, v7, v3
    v_cos_f32 v164, v7
    v_sin_f32 v172, -v7
    v_cos_f32 v165, v8
    v_sin_f32 v173, -v8
    v_fmamk_f32 v7, v3, 0x42c00000, v6
    v_add_f32 v8, v7, v3
    v_cos_f32 v180, v7
    v_sin_f32 v188, -v7
    v_cos_f32 v181, v8
    v_sin_f32 v189, -v8
    v_fma_f32 v166, v5, v165, -v164
    v_fma_f32 v174, v5, v173, -v172
    v_fma_f32 v182, v5, v181, -v180
    v_fma_f32 v190, v5, v189, -v188
    v_fma_f32 v167, v5, v166, -v165
    v_fma_f32 v175, v5, v174, -v173
    v_fma_f32 v183, v5, v182, -v181
    v_fma_f32 v191, v5, v190, -v189
    v_fma_f32 v168, v5, v167, -v166
    v_fma_f32 v176, v5, v175, -v174
    v_fma_f32 v184, v5, v183, -v182
    v_fma_f32 v192, v5, v191, -v190
    v_fma_f32 v169, v5, v168, -v167
    v_fma_f32 v177, v5, v176, -v175
    v_fma_f32 v185, v5, v184, -v183
    v_fma_f32 v193, v5, v192, -v191
    v_fma_f32 v170, v5, v169, -v168
    v_fma_f32 v178, v5, v177, -v176
    v_fma_f32 v186, v5, v185, -v184
    v_fma_f32 v194, v5, v193, -v192
    v_fma_f32 v171, v5, v170, -v169
    v_fma_f32 v179, v5, v178, -v177
    v_fma_f32 v187, v5, v186, -v185
    v_fma_f32 v195, v5, v194, -v193
    v_cvt_pk_bf16_f32 v44, v164, v165
    v_cvt_pk_bf16_f32 v45, v172, v173
    v_cvt_pk_bf16_f32 v46, v168, v169
    v_cvt_pk_bf16_f32 v47, v176, v177
    v_cvt_pk_bf16_f32 v48, v166, v167
    v_cvt_pk_bf16_f32 v49, v174, v175
    v_cvt_pk_bf16_f32 v50, v170, v171
    v_cvt_pk_bf16_f32 v51, v178, v179
    v_cvt_pk_bf16_f32 v52, v180, v181
    v_cvt_pk_bf16_f32 v53, v188, v189
    v_cvt_pk_bf16_f32 v54, v184, v185
    v_cvt_pk_bf16_f32 v55, v192, v193
    v_cvt_pk_bf16_f32 v56, v182, v183
    v_cvt_pk_bf16_f32 v57, v190, v191
    v_cvt_pk_bf16_f32 v58, v186, v187
    v_cvt_pk_bf16_f32 v59, v194, v195
    v_add_f32 v3, 0x3e000000, v3
    v_cos_f32 v5, v3
    v_mul_f32 v6, v3, v4
    v_add_f32 v5, v5, v5
    v_mov_b32 v7, v6
    v_add_f32 v8, v7, v3
    v_cos_f32 v164, v7
    v_sin_f32 v172, -v7
    v_cos_f32 v165, v8
    v_sin_f32 v173, -v8
    v_fmamk_f32 v7, v3, 0x42000000, v6
    v_add_f32 v8, v7, v3
    v_cos_f32 v180, v7
    v_sin_f32 v188, -v7
    v_cos_f32 v181, v8
    v_sin_f32 v189, -v8
    v_fma_f32 v166, v5, v165, -v164
    v_fma_f32 v174, v5, v173, -v172
    v_fma_f32 v182, v5, v181, -v180
    v_fma_f32 v190, v5, v189, -v188
    v_fma_f32 v167, v5, v166, -v165
    v_fma_f32 v175, v5, v174, -v173
    v_fma_f32 v183, v5, v182, -v181
    v_fma_f32 v191, v5, v190, -v189
    v_fma_f32 v168, v5, v167, -v166
    v_fma_f32 v176, v5, v175, -v174
    v_fma_f32 v184, v5, v183, -v182
    v_fma_f32 v192, v5, v191, -v190
    v_fma_f32 v169, v5, v168, -v167
    v_fma_f32 v177, v5, v176, -v175
    v_fma_f32 v185, v5, v184, -v183
    v_fma_f32 v193, v5, v192, -v191
    v_fma_f32 v170, v5, v169, -v168
    v_fma_f32 v178, v5, v177, -v176
    v_fma_f32 v186, v5, v185, -v184
    v_fma_f32 v194, v5, v193, -v192
    v_fma_f32 v171, v5, v170, -v169
    v_fma_f32 v179, v5, v178, -v177
    v_fma_f32 v187, v5, v186, -v185
    v_fma_f32 v195, v5, v194, -v193
    v_cvt_pk_bf16_f32 v60, v164, v165
    v_cvt_pk_bf16_f32 v61, v172, v173
    v_cvt_pk_bf16_f32 v62, v168, v169
    v_cvt_pk_bf16_f32 v63, v176, v177
    v_cvt_pk_bf16_f32 v64, v166, v167
    v_cvt_pk_bf16_f32 v65, v174, v175
    v_cvt_pk_bf16_f32 v66, v170, v171
    v_cvt_pk_bf16_f32 v67, v178, v179
    v_cvt_pk_bf16_f32 v68, v180, v181
    v_cvt_pk_bf16_f32 v69, v188, v189
    v_cvt_pk_bf16_f32 v70, v184, v185
    v_cvt_pk_bf16_f32 v71, v192, v193
    v_cvt_pk_bf16_f32 v72, v182, v183
    v_cvt_pk_bf16_f32 v73, v190, v191
    v_cvt_pk_bf16_f32 v74, v186, v187
    v_cvt_pk_bf16_f32 v75, v194, v195
    v_fmamk_f32 v7, v3, 0x42800000, v6
    v_add_f32 v8, v7, v3
    v_cos_f32 v164, v7
    v_sin_f32 v172, -v7
    v_cos_f32 v165, v8
    v_sin_f32 v173, -v8
    v_fmamk_f32 v7, v3, 0x42c00000, v6
    v_add_f32 v8, v7, v3
    v_cos_f32 v180, v7
    v_sin_f32 v188, -v7
    v_cos_f32 v181, v8
    v_sin_f32 v189, -v8
    v_fma_f32 v166, v5, v165, -v164
    v_fma_f32 v174, v5, v173, -v172
    v_fma_f32 v182, v5, v181, -v180
    v_fma_f32 v190, v5, v189, -v188
    v_fma_f32 v167, v5, v166, -v165
    v_fma_f32 v175, v5, v174, -v173
    v_fma_f32 v183, v5, v182, -v181
    v_fma_f32 v191, v5, v190, -v189
    v_fma_f32 v168, v5, v167, -v166
    v_fma_f32 v176, v5, v175, -v174
    v_fma_f32 v184, v5, v183, -v182
    v_fma_f32 v192, v5, v191, -v190
    v_fma_f32 v169, v5, v168, -v167
    v_fma_f32 v177, v5, v176, -v175
    v_fma_f32 v185, v5, v184, -v183
    v_fma_f32 v193, v5, v192, -v191
    v_fma_f32 v170, v5, v169, -v168
    v_fma_f32 v178, v5, v177, -v176
    v_fma_f32 v186, v5, v185, -v184
    v_fma_f32 v194, v5, v193, -v192
    v_fma_f32 v171, v5, v170, -v169
    v_fma_f32 v179, v5, v178, -v177
    v_fma_f32 v187, v5, v186, -v185
    v_fma_f32 v195, v5, v194, -v193
    v_cvt_pk_bf16_f32 v76, v164, v165
    v_cvt_pk_bf16_f32 v77, v172, v173
    v_cvt_pk_bf16_f32 v78, v168, v169
    v_cvt_pk_bf16_f32 v79, v176, v177
    v_cvt_pk_bf16_f32 v80, v166, v167
    v_cvt_pk_bf16_f32 v81, v174, v175
    v_cvt_pk_bf16_f32 v82, v170, v171
    v_cvt_pk_bf16_f32 v83, v178, v179
    v_cvt_pk_bf16_f32 v84, v180, v181
    v_cvt_pk_bf16_f32 v85, v188, v189
    v_cvt_pk_bf16_f32 v86, v184, v185
    v_cvt_pk_bf16_f32 v87, v192, v193
    v_cvt_pk_bf16_f32 v88, v182, v183
    v_cvt_pk_bf16_f32 v89, v190, v191
    v_cvt_pk_bf16_f32 v90, v186, v187
    v_cvt_pk_bf16_f32 v91, v194, v195
    s_lshl_b32 s61, s56, 9
    s_add_u32 s61, s61, s101
    s_mul_i32 s62, s100, 144
    s_sub_u32 s63, 1008, s62
    v_mov_b32 v16, s62
    v_mov_b32 v17, s63
    v_add_u32 v3, 0, v0
    v_mul_u32_u24 v4, 7282, v3
    v_lshrrev_b32 v4, 16, v4
    v_mul_u32_u24 v5, 9, v4
    v_sub_u32 v5, v3, v5
    v_lshrrev_b32 v6, 1, v4
    v_bfi_b32 v6, 15, v4, v6
    v_lshl_add_u32 v6, v6, 4, s61
    v_and_b32 v4, 16, v4
    v_cmp_ne_u32 vcc, 0, v4
    v_sub_u32 v7, 0, v6
    v_and_b32 v7, 2047, v7
    v_cndmask_b32 v6, v6, v7, vcc
    v_cndmask_b32 v8, v16, v17, vcc
    v_mul_u32_u24 v6, 2304, v6
    v_lshl_add_u32 v5, v5, 4, v8
    v_add_u32 v211, v5, v6
    v_add_u32 v3, 64, v0
    v_mul_u32_u24 v4, 7282, v3
    v_lshrrev_b32 v4, 16, v4
    v_mul_u32_u24 v5, 9, v4
    v_sub_u32 v5, v3, v5
    v_lshrrev_b32 v6, 1, v4
    v_bfi_b32 v6, 15, v4, v6
    v_lshl_add_u32 v6, v6, 4, s61
    v_and_b32 v4, 16, v4
    v_cmp_ne_u32 vcc, 0, v4
    v_sub_u32 v7, 0, v6
    v_and_b32 v7, 2047, v7
    v_cndmask_b32 v6, v6, v7, vcc
    v_cndmask_b32 v8, v16, v17, vcc
    v_mul_u32_u24 v6, 2304, v6
    v_lshl_add_u32 v5, v5, 4, v8
    v_add_u32 v212, v5, v6
    v_add_u32 v3, 128, v0
    v_mul_u32_u24 v4, 7282, v3
    v_lshrrev_b32 v4, 16, v4
    v_mul_u32_u24 v5, 9, v4
    v_sub_u32 v5, v3, v5
    v_lshrrev_b32 v6, 1, v4
    v_bfi_b32 v6, 15, v4, v6
    v_lshl_add_u32 v6, v6, 4, s61
    v_and_b32 v4, 16, v4
    v_cmp_ne_u32 vcc, 0, v4
    v_sub_u32 v7, 0, v6
    v_and_b32 v7, 2047, v7
    v_cndmask_b32 v6, v6, v7, vcc
    v_cndmask_b32 v8, v16, v17, vcc
    v_mul_u32_u24 v6, 2304, v6
    v_lshl_add_u32 v5, v5, 4, v8
    v_add_u32 v213, v5, v6
    v_add_u32 v3, 192, v0
    v_mul_u32_u24 v4, 7282, v3
    v_lshrrev_b32 v4, 16, v4
    v_mul_u32_u24 v5, 9, v4
    v_sub_u32 v5, v3, v5
    v_lshrrev_b32 v6, 1, v4
    v_bfi_b32 v6, 15, v4, v6
    v_lshl_add_u32 v6, v6, 4, s61
    v_and_b32 v4, 16, v4
    v_cmp_ne_u32 vcc, 0, v4
    v_sub_u32 v7, 0, v6
    v_and_b32 v7, 2047, v7
    v_cndmask_b32 v6, v6, v7, vcc
    v_cndmask_b32 v8, v16, v17, vcc
    v_mul_u32_u24 v6, 2304, v6
    v_lshl_add_u32 v5, v5, 4, v8
    v_add_u32 v214, v5, v6
    v_add_u32 v3, 256, v0
    v_mul_u32_u24 v4, 7282, v3
    v_lshrrev_b32 v4, 16, v4
    v_mul_u32_u24 v5, 9, v4
    v_sub_u32 v5, v3, v5
    v_lshrrev_b32 v6, 1, v4
    v_bfi_b32 v6, 15, v4, v6
    v_lshl_add_u32 v6, v6, 4, s61
    v_and_b32 v4, 16, v4
    v_cmp_ne_u32 vcc, 0, v4
    v_sub_u32 v7, 0, v6
    v_and_b32 v7, 2047, v7
    v_cndmask_b32 v6, v6, v7, vcc
    v_cndmask_b32 v8, v16, v17, vcc
    v_mul_u32_u24 v6, 2304, v6
    v_lshl_add_u32 v5, v5, 4, v8
    v_add_u32 v215, v5, v6
    v_cmp_ne_u32 vcc, -1, v11
    s_nop 1
    s_cbranch_vccnz L_pgo_22
L_pok_21:
    s_mov_b32 s26, 65536
L_poll_23:
    buffer_load_dword v10, v221, s[44:47], 0 offen sc1
    s_sub_u32 s26, s26, 1
    s_waitcnt vmcnt(0)
    s_cbranch_scc1 L_pok_24
    v_cmp_eq_u32 vcc, -1, v10
    s_nop 1
    s_cbranch_vccnz L_poll_23
L_pok_24:
    s_barrier
    s_mov_b32 s8, 0
    s_add_u32 m0, s3, 0
    s_nop 0
    buffer_load_dwordx4 v228, s[44:47], s8 offen sc1 lds
    s_mov_b32 s8, 4096
    s_add_u32 m0, s3, 4096
    s_nop 0
    buffer_load_dwordx4 v228, s[44:47], s8 offen sc1 lds
    s_mov_b32 s8, 8192
    s_add_u32 m0, s3, 8192
    s_nop 0
    buffer_load_dwordx4 v228, s[44:47], s8 offen sc1 lds
    s_mov_b32 s8, 12288
    s_add_u32 m0, s3, 12288
    s_nop 0
    buffer_load_dwordx4 v228, s[44:47], s8 offen sc1 lds
    s_mov_b32 s8, 16384
    s_add_u32 m0, s3, 16384
    s_nop 0
    buffer_load_dwordx4 v228, s[44:47], s8 offen sc1 lds
    s_mov_b32 s8, 20480
    s_add_u32 m0, s3, 20480
    s_nop 0
    buffer_load_dwordx4 v228, s[44:47], s8 offen sc1 lds
    s_mov_b32 s8, 24576
    s_add_u32 m0, s3, 24576
    s_nop 0
    buffer_load_dwordx4 v228, s[44:47], s8 offen sc1 lds
    s_mov_b32 s8, 28672
    s_add_u32 m0, s3, 28672
    s_nop 0
    buffer_load_dwordx4 v228, s[44:47], s8 offen sc1 lds
    v_add_u32 v3, 320, v0
    v_mul_u32_u24 v4, 7282, v3
    v_lshrrev_b32 v4, 16, v4
    v_mul_u32_u24 v5, 9, v4
    v_sub_u32 v5, v3, v5
    v_lshrrev_b32 v6, 1, v4
    v_bfi_b32 v6, 15, v4, v6
    v_lshl_add_u32 v6, v6, 4, s61
    v_and_b32 v4, 16, v4
    v_cmp_ne_u32 vcc, 0, v4
    v_sub_u32 v7, 0, v6
    v_and_b32 v7, 2047, v7
    v_cndmask_b32 v6, v6, v7, vcc
    v_cndmask_b32 v8, v16, v17, vcc
    v_mul_u32_u24 v6, 2304, v6
    v_lshl_add_u32 v5, v5, 4, v8
    v_add_u32 v216, v5, v6
    v_add_u32 v3, 384, v0
    v_mul_u32_u24 v4, 7282, v3
    v_lshrrev_b32 v4, 16, v4
    v_mul_u32_u24 v5, 9, v4
    v_sub_u32 v5, v3, v5
    v_lshrrev_b32 v6, 1, v4
    v_bfi_b32 v6, 15, v4, v6
    v_lshl_add_u32 v6, v6, 4, s61
    v_and_b32 v4, 16, v4
    v_cmp_ne_u32 vcc, 0, v4
    v_sub_u32 v7, 0, v6
    v_and_b32 v7, 2047, v7
    v_cndmask_b32 v6, v6, v7, vcc
    v_cndmask_b32 v8, v16, v17, vcc
    v_mul_u32_u24 v6, 2304, v6
    v_lshl_add_u32 v5, v5, 4, v8
    v_add_u32 v217, v5, v6
    v_add_u32 v3, 448, v0
    s_mov_b32 s8, 32768
    s_add_u32 m0, s3, 32768
    s_nop 0
    buffer_load_dwordx4 v228, s[44:47], s8 offen sc1 lds
    v_mul_u32_u24 v4, 7282, v3
    v_lshrrev_b32 v4, 16, v4
    v_mul_u32_u24 v5, 9, v4
    v_sub_u32 v5, v3, v5
    v_lshrrev_b32 v6, 1, v4
    v_bfi_b32 v6, 15, v4, v6
    v_lshl_add_u32 v6, v6, 4, s61
    v_and_b32 v4, 16, v4
    v_cmp_ne_u32 vcc, 0, v4
    v_sub_u32 v7, 0, v6
    v_and_b32 v7, 2047, v7
    v_cndmask_b32 v6, v6, v7, vcc
    v_cndmask_b32 v8, v16, v17, vcc
    v_mul_u32_u24 v6, 2304, v6
    v_lshl_add_u32 v5, v5, 4, v8
    v_add_u32 v218, v5, v6
    v_add_u32 v3, 512, v0
    s_mov_b32 s8, 36864
    s_add_u32 m0, s3, 36864
    s_nop 0
    buffer_load_dwordx4 v228, s[44:47], s8 offen sc1 lds
    v_mul_u32_u24 v4, 7282, v3
    v_lshrrev_b32 v4, 16, v4
    v_mul_u32_u24 v5, 9, v4
    v_sub_u32 v5, v3, v5
    v_lshrrev_b32 v6, 1, v4
    v_bfi_b32 v6, 15, v4, v6
    v_lshl_add_u32 v6, v6, 4, s61
    v_and_b32 v4, 16, v4
    v_cmp_ne_u32 vcc, 0, v4
    v_sub_u32 v7, 0, v6
    v_and_b32 v7, 2047, v7
    v_cndmask_b32 v6, v6, v7, vcc
    v_cndmask_b32 v8, v16, v17, vcc
    v_mul_u32_u24 v6, 2304, v6
    v_lshl_add_u32 v5, v5, 4, v8
    v_add_u32 v219, v5, v6
    s_waitcnt vmcnt(5)
    s_barrier
    ds_read_b64 a[0:1], v14 offset:0
    ds_read_b64 a[2:3], v14 offset:5120
    ds_read_b64 a[4:5], v15 offset:0
    ds_read_b64 a[6:7], v15 offset:5120
    ds_read_b64 a[8:9], v14 offset:256
    ds_read_b64 a[10:11], v14 offset:5376
    ds_read_b64 a[12:13], v15 offset:256
    ds_read_b64 a[14:15], v15 offset:5376
    ds_read_b64 a[16:17], v227 offset:512
    ds_read_b64 a[18:19], v227 offset:5632
    s_waitcnt lgkmcnt(8)
    v_mfma_f32_16x16x32_bf16 v[124:127], a[0:3], v[28:31], 0
    ds_read_b64 a[20:21], v14 offset:2560
    ds_read_b64 a[22:23], v14 offset:7680
    v_mfma_f32_16x16x32_bf16 v[144:147], a[0:3], v[60:63], 0
    ds_read_b64 a[24:25], v15 offset:2560
    s_waitcnt lgkmcnt(9)
    v_mfma_f32_16x16x32_bf16 v[128:131], a[4:7], v[28:31], 0
    ds_read_b64 a[26:27], v15 offset:7680
    ds_read_b64 a[28:29], v14 offset:2816
    v_mfma_f32_16x16x32_bf16 v[148:151], a[4:7], v[60:63], 0
    ds_read_b64 a[30:31], v14 offset:7936
    s_waitcnt lgkmcnt(10)
    v_mfma_f32_16x16x32_bf16 v[132:135], a[8:11], v[28:31], 0
    ds_read_b64 a[32:33], v15 offset:2816
    ds_read_b64 a[34:35], v15 offset:7936
    v_mfma_f32_16x16x32_bf16 v[152:155], a[8:11], v[60:63], 0
    ds_read_b64 a[36:37], v227 offset:3072
    s_waitcnt lgkmcnt(11)
    v_mfma_f32_16x16x32_bf16 v[136:139], a[12:15], v[28:31], 0
    ds_read_b64 a[38:39], v227 offset:8192
    v_mfma_f32_16x16x32_bf16 v[156:159], a[12:15], v[60:63], 0
    s_waitcnt lgkmcnt(10)
    v_mfma_f32_16x16x32_bf16 v[140:143], a[16:19], v[28:31], 0
    v_mfma_f32_16x16x32_bf16 v[160:163], a[16:19], v[60:63], 0
    s_waitcnt lgkmcnt(8)
    v_mfma_f32_16x16x32_bf16 v[124:127], a[20:23], v[32:35], v[124:127]
    ds_read_b64 a[40:41], v14 offset:10240
    ds_read_b64 a[42:43], v14 offset:15360
    v_mfma_f32_16x16x32_bf16 v[144:147], a[20:23], v[64:67], v[144:147]
    ds_read_b64 a[44:45], v15 offset:10240
    s_waitcnt lgkmcnt(9)
    v_mfma_f32_16x16x32_bf16 v[128:131], a[24:27], v[32:35], v[128:131]
    ds_read_b64 a[46:47], v15 offset:15360
    ds_read_b64 a[48:49], v14 offset:10496
    v_mfma_f32_16x16x32_bf16 v[148:151], a[24:27], v[64:67], v[148:151]
    ds_read_b64 a[50:51], v14 offset:15616
    s_waitcnt lgkmcnt(10)
    v_mfma_f32_16x16x32_bf16 v[132:135], a[28:31], v[32:35], v[132:135]
    ds_read_b64 a[52:53], v15 offset:10496
    ds_read_b64 a[54:55], v15 offset:15616
    v_mfma_f32_16x16x32_bf16 v[152:155], a[28:31], v[64:67], v[152:155]
    ds_read_b64 a[56:57], v227 offset:10752
    s_waitcnt lgkmcnt(11)
    v_mfma_f32_16x16x32_bf16 v[136:139], a[32:35], v[32:35], v[136:139]
    ds_read_b64 a[58:59], v227 offset:15872
    v_mfma_f32_16x16x32_bf16 v[156:159], a[32:35], v[64:67], v[156:159]
    s_waitcnt lgkmcnt(10)
    v_mfma_f32_16x16x32_bf16 v[140:143], a[36:39], v[32:35], v[140:143]
    v_mfma_f32_16x16x32_bf16 v[160:163], a[36:39], v[64:67], v[160:163]
    s_waitcnt lgkmcnt(8)
    v_mfma_f32_16x16x32_bf16 v[124:127], a[40:43], v[36:39], v[124:127]
    ds_read_b64 a[60:61], v14 offset:12800
    ds_read_b64 a[62:63], v14 offset:17920
    v_mfma_f32_16x16x32_bf16 v[144:147], a[40:43], v[68:71], v[144:147]
    ds_read_b64 a[64:65], v15 offset:12800
    s_waitcnt lgkmcnt(9)
    v_mfma_f32_16x16x32_bf16 v[128:131], a[44:47], v[36:39], v[128:131]
    ds_read_b64 a[66:67], v15 offset:17920
    ds_read_b64 a[68:69], v14 offset:13056
    v_mfma_f32_16x16x32_bf16 v[148:151], a[44:47], v[68:71], v[148:151]
    ds_read_b64 a[70:71], v14 offset:18176
    s_waitcnt lgkmcnt(10)
    v_mfma_f32_16x16x32_bf16 v[132:135], a[48:51], v[36:39], v[132:135]
    ds_read_b64 a[72:73], v15 offset:13056
    ds_read_b64 a[74:75], v15 offset:18176
    v_mfma_f32_16x16x32_bf16 v[152:155], a[48:51], v[68:71], v[152:155]
    ds_read_b64 a[76:77], v227 offset:13312
    s_waitcnt lgkmcnt(11)
    v_mfma_f32_16x16x32_bf16 v[136:139], a[52:55], v[36:39], v[136:139]
    ds_read_b64 a[78:79], v227 offset:18432
    v_mfma_f32_16x16x32_bf16 v[156:159], a[52:55], v[68:71], v[156:159]
    s_waitcnt lgkmcnt(10)
    v_mfma_f32_16x16x32_bf16 v[140:143], a[56:59], v[36:39], v[140:143]
    v_mfma_f32_16x16x32_bf16 v[160:163], a[56:59], v[68:71], v[160:163]
    s_waitcnt vmcnt(0)
    s_barrier
    s_waitcnt lgkmcnt(8)
    v_mfma_f32_16x16x32_bf16 v[124:127], a[60:63], v[40:43], v[124:127]
    ds_read_b64 a[80:81], v14 offset:20480
    ds_read_b64 a[82:83], v14 offset:25600
    v_mfma_f32_16x16x32_bf16 v[144:147], a[60:63], v[72:75], v[144:147]
    ds_read_b64 a[84:85], v15 offset:20480
    ds_read_b64 a[86:87], v15 offset:25600
    s_waitcnt lgkmcnt(10)
    v_mfma_f32_16x16x32_bf16 v[128:131], a[64:67], v[40:43], v[128:131]
    ds_read_b64 a[88:89], v14 offset:20736
    ds_read_b64 a[90:91], v14 offset:25856
    v_mfma_f32_16x16x32_bf16 v[148:151], a[64:67], v[72:75], v[148:151]
    ds_read_b64 a[92:93], v15 offset:20736
    ds_read_b64 a[94:95], v15 offset:25856
    s_waitcnt lgkmcnt(12)
    v_mfma_f32_16x16x32_bf16 v[132:135], a[68:71], v[40:43], v[132:135]
    ds_read_b64 a[96:97], v227 offset:20992
    ds_read_b64 a[98:99], v227 offset:26112
    v_mfma_f32_16x16x32_bf16 v[152:155], a[68:71], v[72:75], v[152:155]
    ds_read_b64 a[100:101], v14 offset:23040
    ds_read_b64 a[102:103], v14 offset:28160
    s_waitcnt lgkmcnt(14)
    v_mfma_f32_16x16x32_bf16 v[136:139], a[72:75], v[40:43], v[136:139]
    ds_read_b64 a[104:105], v15 offset:23040
    ds_read_b64 a[106:107], v15 offset:28160
    v_mfma_f32_16x16x32_bf16 v[156:159], a[72:75], v[72:75], v[156:159]
    ds_read_b64 a[108:109], v14 offset:23296
    ds_read_b64 a[110:111], v14 offset:28416
    s_waitcnt lgkmcnt(15)
    v_mfma_f32_16x16x32_bf16 v[140:143], a[76:79], v[40:43], v[140:143]
    ds_read_b64 a[112:113], v15 offset:23296
    ds_read_b64 a[114:115], v15 offset:28416
    v_mfma_f32_16x16x32_bf16 v[160:163], a[76:79], v[72:75], v[160:163]
    ds_read_b64 a[116:117], v227 offset:23552
    ds_read_b64 a[118:119], v227 offset:28672
    s_waitcnt lgkmcnt(15)
    v_mfma_f32_16x16x32_bf16 v[124:127], a[80:83], v[44:47], v[124:127]
    ds_read_b64 a[120:121], v14 offset:30720
    ds_read_b64 a[122:123], v14 offset:35840
    v_mfma_f32_16x16x32_bf16 v[128:131], a[84:87], v[44:47], v[128:131]
    ds_read_b64 a[124:125], v15 offset:30720
    ds_read_b64 a[126:127], v15 offset:35840
    s_waitcnt lgkmcnt(15)
    v_mfma_f32_16x16x32_bf16 v[132:135], a[88:91], v[44:47], v[132:135]
    ds_read_b64 a[128:129], v14 offset:30976
    ds_read_b64 a[130:131], v14 offset:36096
    v_mfma_f32_16x16x32_bf16 v[136:139], a[92:95], v[44:47], v[136:139]
    ds_read_b64 a[132:133], v15 offset:30976
    ds_read_b64 a[134:135], v15 offset:36096
    s_waitcnt lgkmcnt(15)
    v_mfma_f32_16x16x32_bf16 v[140:143], a[96:99], v[44:47], v[140:143]
    ds_read_b64 a[136:137], v227 offset:31232
    ds_read_b64 a[138:139], v227 offset:36352
    v_mfma_f32_16x16x32_bf16 v[124:127], a[100:103], v[48:51], v[124:127]
    ds_read_b64 a[140:141], v14 offset:33280
    ds_read_b64 a[142:143], v14 offset:38400
    s_waitcnt lgkmcnt(15)
    v_mfma_f32_16x16x32_bf16 v[128:131], a[104:107], v[48:51], v[128:131]
    ds_read_b64 a[144:145], v15 offset:33280
    ds_read_b64 a[146:147], v15 offset:38400
    v_mfma_f32_16x16x32_bf16 v[132:135], a[108:111], v[48:51], v[132:135]
    ds_read_b64 a[148:149], v14 offset:33536
    ds_read_b64 a[150:151], v14 offset:38656
    s_waitcnt lgkmcnt(15)
    v_mfma_f32_16x16x32_bf16 v[136:139], a[112:115], v[48:51], v[136:139]
    ds_read_b64 a[152:153], v15 offset:33536
    ds_read_b64 a[154:155], v15 offset:38656
    v_mfma_f32_16x16x32_bf16 v[140:143], a[116:119], v[48:51], v[140:143]
    ds_read_b64 a[156:157], v227 offset:33792
    ds_read_b64 a[158:159], v227 offset:38912
    s_waitcnt lgkmcnt(15)
    v_mfma_f32_16x16x32_bf16 v[124:127], a[120:123], v[52:55], v[124:127]
    v_mfma_f32_16x16x32_bf16 v[128:131], a[124:127], v[52:55], v[128:131]
    s_waitcnt lgkmcnt(14)
    v_mfma_f32_16x16x32_bf16 v[132:135], a[128:131], v[52:55], v[132:135]
    s_waitcnt lgkmcnt(12)
    v_mfma_f32_16x16x32_bf16 v[136:139], a[132:135], v[52:55], v[136:139]
    s_waitcnt lgkmcnt(10)
    v_mfma_f32_16x16x32_bf16 v[140:143], a[136:139], v[52:55], v[140:143]
    s_waitcnt lgkmcnt(8)
    v_mfma_f32_16x16x32_bf16 v[124:127], a[140:143], v[56:59], v[124:127]
    s_waitcnt lgkmcnt(6)
    v_mfma_f32_16x16x32_bf16 v[128:131], a[144:147], v[56:59], v[128:131]
    s_waitcnt lgkmcnt(4)
    v_mfma_f32_16x16x32_bf16 v[132:135], a[148:151], v[56:59], v[132:135]
    s_waitcnt lgkmcnt(2)
    v_mfma_f32_16x16x32_bf16 v[136:139], a[152:155], v[56:59], v[136:139]
    s_waitcnt lgkmcnt(0)
    v_mfma_f32_16x16x32_bf16 v[140:143], a[156:159], v[56:59], v[140:143]
    v_mfma_f32_16x16x32_bf16 v[144:147], a[80:83], v[76:79], v[144:147]
    v_mfma_f32_16x16x32_bf16 v[148:151], a[84:87], v[76:79], v[148:151]
    v_cvt_pk_bf16_f32 v164, v124, v125
    ds_write_b32 v224, v164 offset:0
    v_mfma_f32_16x16x32_bf16 v[152:155], a[88:91], v[76:79], v[152:155]
    v_cvt_pk_bf16_f32 v165, v126, v125
    ds_write_b32 v225, v165 offset:32
    v_mfma_f32_16x16x32_bf16 v[156:159], a[92:95], v[76:79], v[156:159]
    v_cvt_pk_bf16_f32 v166, v126, v127
    ds_write_b32 v224, v166 offset:4
    v_mfma_f32_16x16x32_bf16 v[160:163], a[96:99], v[76:79], v[160:163]
    v_cvt_pk_bf16_f32 v167, v128, v127
    ds_write_b32 v225, v167 offset:28
    v_mfma_f32_16x16x32_bf16 v[144:147], a[100:103], v[80:83], v[144:147]
    v_cvt_pk_bf16_f32 v168, v128, v129
    ds_write_b32 v224, v168 offset:8
    v_mfma_f32_16x16x32_bf16 v[148:151], a[104:107], v[80:83], v[148:151]
    v_cvt_pk_bf16_f32 v169, v130, v129
    ds_write_b32 v225, v169 offset:24
    v_mfma_f32_16x16x32_bf16 v[152:155], a[108:111], v[80:83], v[152:155]
    v_cvt_pk_bf16_f32 v170, v130, v131
    ds_write_b32 v224, v170 offset:12
    v_mfma_f32_16x16x32_bf16 v[156:159], a[112:115], v[80:83], v[156:159]
    v_cvt_pk_bf16_f32 v171, v132, v131
    ds_write_b32 v225, v171 offset:20
    v_mfma_f32_16x16x32_bf16 v[160:163], a[116:119], v[80:83], v[160:163]
    v_cvt_pk_bf16_f32 v172, v132, v133
    ds_write_b32 v224, v172 offset:16
    v_mfma_f32_16x16x32_bf16 v[144:147], a[120:123], v[84:87], v[144:147]
    v_cvt_pk_bf16_f32 v173, v134, v133
    ds_write_b32 v225, v173 offset:16
    v_mfma_f32_16x16x32_bf16 v[148:151], a[124:127], v[84:87], v[148:151]
    v_cvt_pk_bf16_f32 v174, v134, v135
    ds_write_b32 v224, v174 offset:20
    v_mfma_f32_16x16x32_bf16 v[152:155], a[128:131], v[84:87], v[152:155]
    v_cvt_pk_bf16_f32 v175, v136, v135
    ds_write_b32 v225, v175 offset:12
    v_mfma_f32_16x16x32_bf16 v[156:159], a[132:135], v[84:87], v[156:159]
    v_cvt_pk_bf16_f32 v176, v136, v137
    ds_write_b32 v224, v176 offset:24
    v_mfma_f32_16x16x32_bf16 v[160:163], a[136:139], v[84:87], v[160:163]
    v_cvt_pk_bf16_f32 v177, v138, v137
    ds_write_b32 v225, v177 offset:8
    v_mfma_f32_16x16x32_bf16 v[144:147], a[140:143], v[88:91], v[144:147]
    v_cvt_pk_bf16_f32 v178, v138, v139
    ds_write_b32 v224, v178 offset:28
    v_mfma_f32_16x16x32_bf16 v[148:151], a[144:147], v[88:91], v[148:151]
    v_cvt_pk_bf16_f32 v179, v140, v139
    ds_write_b32 v225, v179 offset:4
    v_mfma_f32_16x16x32_bf16 v[152:155], a[148:151], v[88:91], v[152:155]
    v_cvt_pk_bf16_f32 v180, v140, v141
    ds_write_b32 v224, v180 offset:32
    v_mfma_f32_16x16x32_bf16 v[156:159], a[152:155], v[88:91], v[156:159]
    v_cvt_pk_bf16_f32 v181, v142, v141
    ds_write_b32 v225, v181 offset:0
    v_mfma_f32_16x16x32_bf16 v[160:163], a[156:159], v[88:91], v[160:163]
    ds_read_b128 v[92:95], v226 offset:0
    ds_read_b128 v[96:99], v226 offset:1024
    ds_read_b128 v[100:103], v226 offset:2048
    ds_read_b128 v[104:107], v226 offset:3072
    v_cvt_pk_bf16_f32 v182, v144, v145
    ds_write_b32 v224, v182 offset:4608
    v_cvt_pk_bf16_f32 v183, v146, v145
    ds_write_b32 v225, v183 offset:4640
    v_cvt_pk_bf16_f32 v184, v146, v147
    ds_write_b32 v224, v184 offset:4612
    v_cvt_pk_bf16_f32 v185, v148, v147
    ds_write_b32 v225, v185 offset:4636
    v_cvt_pk_bf16_f32 v186, v148, v149
    ds_write_b32 v224, v186 offset:4616
    s_waitcnt lgkmcnt(8)
    buffer_store_dwordx4 v[92:95], v211, s[48:51], 0 offen
    v_cvt_pk_bf16_f32 v187, v150, v149
    ds_write_b32 v225, v187 offset:4632
    v_cvt_pk_bf16_f32 v188, v150, v151
    ds_write_b32 v224, v188 offset:4620
    v_cvt_pk_bf16_f32 v189, v152, v151
    ds_write_b32 v225, v189 offset:4628
    s_waitcnt lgkmcnt(10)
    buffer_store_dwordx4 v[96:99], v212, s[48:51], 0 offen
    v_cvt_pk_bf16_f32 v190, v152, v153
    ds_write_b32 v224, v190 offset:4624
    v_cvt_pk_bf16_f32 v191, v154, v153
    ds_write_b32 v225, v191 offset:4624
    v_cvt_pk_bf16_f32 v192, v154, v155
    ds_write_b32 v224, v192 offset:4628
    v_cvt_pk_bf16_f32 v193, v156, v155
    ds_write_b32 v225, v193 offset:4620
    s_waitcnt lgkmcnt(13)
    buffer_store_dwordx4 v[100:103], v213, s[48:51], 0 offen
    v_cvt_pk_bf16_f32 v194, v156, v157
    ds_write_b32 v224, v194 offset:4632
    v_cvt_pk_bf16_f32 v195, v158, v157
    ds_write_b32 v225, v195 offset:4616
    v_cvt_pk_bf16_f32 v196, v158, v159
    ds_write_b32 v224, v196 offset:4636
    s_waitcnt lgkmcnt(15)
    buffer_store_dwordx4 v[104:107], v214, s[48:51], 0 offen
    v_cvt_pk_bf16_f32 v197, v160, v159
    ds_write_b32 v225, v197 offset:4612
    v_cvt_pk_bf16_f32 v198, v160, v161
    ds_write_b32 v224, v198 offset:4640
    v_cvt_pk_bf16_f32 v199, v162, v161
    ds_write_b32 v225, v199 offset:4608
    ds_read_b128 v[44:47], v226 offset:4096
    ds_read_b128 v[48:51], v226 offset:5120
    ds_read_b128 v[52:55], v226 offset:6144
    ds_read_b128 v[56:59], v226 offset:7168
    ds_read_b128 v[60:63], v226 offset:8192
    s_waitcnt lgkmcnt(4)
    buffer_store_dwordx4 v[44:47], v215, s[48:51], 0 offen
    s_waitcnt lgkmcnt(3)
    buffer_store_dwordx4 v[48:51], v216, s[48:51], 0 offen
    s_waitcnt lgkmcnt(2)
    buffer_store_dwordx4 v[52:55], v217, s[48:51], 0 offen
    s_waitcnt lgkmcnt(1)
    buffer_store_dwordx4 v[56:59], v218, s[48:51], 0 offen
    s_waitcnt lgkmcnt(0)
    buffer_store_dwordx4 v[60:63], v219, s[48:51], 0 offen
    s_endpgm
L_pgo_22:
    s_mov_b32 s26, 65536
L_poll_20:
    buffer_load_dword v11, v230, s[52:55], 0 offen sc1
    s_sub_u32 s26, s26, 1
    s_waitcnt vmcnt(0)
    s_cbranch_scc1 L_pok_21
    v_cmp_ne_u32 vcc, -1, v11
    s_nop 1
    s_cbranch_vccnz L_poll_20
    s_branch L_pok_21
L_end:
    s_endpgm
.section .rodata,"a"
.p2align 6
.amdhsa_kernel concat_heads__spectral_fnet__sliding_local_dilated__prompt_kernel
  .amdhsa_next_free_vgpr 512
  .amdhsa_next_free_sgpr 102
  .amdhsa_accum_offset 256
  .amdhsa_group_segment_fixed_size 0
  .amdhsa_kernarg_size 88
  .amdhsa_user_sgpr_count 2
  .amdhsa_user_sgpr_kernarg_segment_ptr 1
  .amdhsa_system_sgpr_workgroup_id_x 1
.end_amdhsa_kernel
```
